```python
import torch

def _softmax(x, axis=-1):
    return torch.softmax(x, dim=axis)
def _gelu(x):
    return torch.nn.functional.gelu(x, approximate="tanh")
def _silu(x):
    return torch.nn.functional.silu(x)
def _sigmoid(x):
    return torch.sigmoid(x)
def _layernorm(x, axis=-1, eps=1e-5):
    m = x.mean(dim=axis, keepdim=True)
    v = x.var(dim=axis, keepdim=True, unbiased=False)
    return (x - m) / torch.sqrt(v + eps)
def _scatter_add(tgt, idx, src, axis=0):
    return tgt.clone().index_add_(axis, idx, src)
def _segment_sum(src, seg, n):
    out = torch.zeros((n,) + src.shape[1:], dtype=src.dtype)
    return out.index_add_(0, seg, src)
def _pad(x, pw):
    flat = tuple(v for pair in reversed(pw) for v in pair)
    return torch.nn.functional.pad(x, flat)

kernel_name = 'gated_mix__gqa_block_cached__geglu_ffn__decode'

def setup_inputs():

    _w = (lambda a: (lambda t: t.to(torch.bfloat16) if t.is_floating_point() else t)(torch.as_tensor(a)))
    def _A_setup():
        B, Sq, D = 1, 1, 448
        Hq, Hkv, Sk, Dh = 16, 8, 65536, 256
        assert Hq % Hkv == 0, (Hq, Hkv)
        return {
            "x": _w((lambda *s: torch.randn(*s, dtype=torch.bfloat16) * 0.05)(B, Sq, D)),
            "k_cache": _w((lambda *s: torch.randn(*s, dtype=torch.bfloat16) * 6.4)(B, Hkv, Sk, Dh)),
            "v_cache": _w((lambda *s: torch.randn(*s, dtype=torch.bfloat16) * 0.2)(B, Hkv, Sk, Dh)),
            "wq": _w((lambda *s: torch.randn(*s, dtype=torch.bfloat16) * 6.4)(D, Hq * Dh) * (D ** -0.5)),
            "wo": _w((lambda *s: torch.randn(*s, dtype=torch.bfloat16) * 0.2)(Hq * Dh, D) * ((Hq * Dh) ** -0.5)),
        }
    _A_in = _A_setup()

    def _B_setup():
        B, S, D, F = 1, 1, 448, 1792
        return {
            "x": _w((lambda *s: torch.randn(*s, dtype=torch.bfloat16) * 0.05)(B, S, D)),
            "w_gate": _w((lambda *s: torch.randn(*s, dtype=torch.bfloat16) * 0.05)(D, F)),
            "w_up": _w((lambda *s: torch.randn(*s, dtype=torch.bfloat16) * 0.05)(D, F)),
            "w_down": _w((lambda *s: torch.randn(*s, dtype=torch.bfloat16) * 0.05)(F, D)),
        }
    _B_in = _B_setup()

    return {
        "A_x": _A_in["x"],
        "A_k_cache": _A_in["k_cache"],
        "A_v_cache": _A_in["v_cache"],
        "A_wq": _A_in["wq"],
        "A_wo": _A_in["wo"],
        "B_x": _B_in["x"],
        "B_w_gate": _B_in["w_gate"],
        "B_w_up": _B_in["w_up"],
        "B_w_down": _B_in["w_down"],
        "gate_w": _w((lambda *s: torch.randn(*s, dtype=torch.bfloat16) * 0.05)(448) * 16.0),
    }

def reference(A_x, A_k_cache, A_v_cache, A_wq, A_wo, B_x, B_w_gate, B_w_up, B_w_down, gate_w):
    def _A_ref(x, k_cache, v_cache, wq, wo):
        B, Sq, D = x.shape
        Hq, Dh = 16, 256
        Hkv = k_cache.shape[1]
        rep = Hq // Hkv
        q = (lambda x, *d: x.permute(*d))((x @ wq).reshape(B, Sq, Hq, Dh), 0, 2, 1, 3)
        k = (lambda x, n, axis: torch.repeat_interleave(x, n, dim=axis))(k_cache, rep, axis=1)
        v = (lambda x, n, axis: torch.repeat_interleave(x, n, dim=axis))(v_cache, rep, axis=1)
        scores = torch.einsum("bhqd,bhkd->bhqk", q, k) * (Dh ** -0.5)
        p = _softmax(scores, axis=-1)
        o = torch.einsum("bhqk,bhkd->bhqd", p, v)
        return (lambda x, *d: x.permute(*d))(o, 0, 2, 1, 3).reshape(B, Sq, Hq * Dh) @ wo

    def _B_ref(x, w_gate, w_up, w_down):
        return (_gelu(x @ w_gate) * (x @ w_up)) @ w_down

    x = A_x
    g = _sigmoid((x * gate_w).sum(-1, keepdims=True))
    a = _A_ref(x, A_k_cache, A_v_cache, A_wq, A_wo)
    b = _B_ref(x, B_w_gate, B_w_up, B_w_down)
    return g * a + (1 - g) * b
```

```asm
; @launch grid=(256,1,1) block=(256,1,1) lds=18432
.amdgcn_target "amdgcn-amd-amdhsa--gfx950"
.text
.globl gated_mix__gqa_block_cached__geglu_ffn__decode_kernel
.p2align 8
.type gated_mix__gqa_block_cached__geglu_ffn__decode_kernel,@function
gated_mix__gqa_block_cached__geglu_ffn__decode_kernel:

    s_cmp_ge_u32 s2, 256
    s_cbranch_scc1 L_end
    s_load_dwordx16 s[16:31], s[0:1], 0
    s_mov_b32 s100, s2
    s_and_b32 s3, s2, 7
    s_lshr_b32 s2, s2, 3
    s_lshl_b32 s3, s3, 5
    s_or_b32 s2, s2, s3
    s_load_dwordx8 s[32:39], s[0:1], 64
    s_load_dwordx2 s[40:41], s[0:1], 96
    v_lshrrev_b32 v1, 6, v0
    v_and_b32 v0, 63, v0
    v_readfirstlane_b32 s3, v1
    s_mov_b32 s60, 0x05040100
    s_mov_b32 s61, 0x07060302
    s_waitcnt lgkmcnt(0)
    s_mov_b32 s12, s40
    s_mov_b32 s13, s41
    s_mov_b32 s14, 0x500000
    s_mov_b32 s15, 0x00020000
    s_cmp_eq_u32 s3, 2
    s_cbranch_scc1 L_auxA
    s_cmp_eq_u32 s3, 3
    s_cbranch_scc1 L_auxB
    s_bfe_u32 s49, s2, 0x20000
    s_lshl_b32 s49, s49, 14
    s_bfe_u32 s48, s2, 0x10002
    s_lshl_b32 s48, s48, 22
    s_xor_b32 s49, s49, s48
    s_bfe_u32 s48, s2, 0x10003
    s_lshl_b32 s48, s48, 21
    s_xor_b32 s49, s49, s48
    s_bitcmp1_b32 s2, 4
    s_cselect_b32 s48, 0x1800000, 0
    s_xor_b32 s49, s49, s48
    s_bfe_u32 s48, s2, 0x30005
    s_lshl_b32 s48, s48, 25
    s_xor_b32 s49, s49, s48
    s_bfe_u32 s48, s3, 0x10000
    s_lshl_b32 s48, s48, 13
    s_xor_b32 s49, s49, s48
    s_mov_b32 s4, s18
    s_mov_b32 s5, s19
    s_mov_b32 s6, 0x10000000
    s_mov_b32 s7, 0x00020000
    v_and_b32 v13, 15, v0
    v_lshrrev_b32 v14, 4, v0
    v_bfe_u32 v9, v0, 1, 1
    v_lshlrev_b32 v9, 2, v9
    v_bfe_u32 v10, v0, 4, 1
    v_lshl_or_b32 v9, v10, 3, v9
    v_bfe_u32 v11, v0, 0, 1
    v_lshlrev_b32 v11, 4, v11
    v_bfe_u32 v10, v0, 5, 1
    v_lshl_or_b32 v11, v10, 5, v11
    v_bfe_u32 v10, v0, 2, 2
    v_lshl_or_b32 v11, v10, 11, v11
    s_mov_b32 s48, 0x4210
    v_lshrrev_b32 v1, v9, s48
    v_and_b32 v1, 15, v1
    v_lshl_or_b32 v1, v1, 6, v11
    s_mov_b32 s48, 0x3765
    v_lshrrev_b32 v2, v9, s48
    v_and_b32 v2, 15, v2
    v_lshl_or_b32 v2, v2, 6, v11
    s_barrier
    s_xor_b32 s48, s49, 0x0
    buffer_load_dwordx4 a[0:3], v1, s[4:7], s48 offen offset:0 nt
    buffer_load_dwordx4 a[4:7], v2, s[4:7], s48 offen offset:0 nt
    buffer_load_dwordx4 a[8:11], v1, s[4:7], s48 offen offset:512 nt
    buffer_load_dwordx4 a[12:15], v2, s[4:7], s48 offen offset:512 nt
    buffer_load_dwordx4 a[16:19], v1, s[4:7], s48 offen offset:1024 nt
    buffer_load_dwordx4 a[20:23], v2, s[4:7], s48 offen offset:1024 nt
    buffer_load_dwordx4 a[24:27], v1, s[4:7], s48 offen offset:1536 nt
    buffer_load_dwordx4 a[28:31], v2, s[4:7], s48 offen offset:1536 nt
    s_xor_b32 s48, s49, 0x10000
    buffer_load_dwordx4 a[32:35], v1, s[4:7], s48 offen offset:0 nt
    buffer_load_dwordx4 a[36:39], v2, s[4:7], s48 offen offset:0 nt
    buffer_load_dwordx4 a[40:43], v1, s[4:7], s48 offen offset:512 nt
    buffer_load_dwordx4 a[44:47], v2, s[4:7], s48 offen offset:512 nt
    buffer_load_dwordx4 a[48:51], v1, s[4:7], s48 offen offset:1024 nt
    buffer_load_dwordx4 a[52:55], v2, s[4:7], s48 offen offset:1024 nt
    buffer_load_dwordx4 a[56:59], v1, s[4:7], s48 offen offset:1536 nt
    buffer_load_dwordx4 a[60:63], v2, s[4:7], s48 offen offset:1536 nt
    s_xor_b32 s48, s49, 0x20000
    buffer_load_dwordx4 a[64:67], v1, s[4:7], s48 offen offset:0 nt
    buffer_load_dwordx4 a[68:71], v2, s[4:7], s48 offen offset:0 nt
    buffer_load_dwordx4 a[72:75], v1, s[4:7], s48 offen offset:512 nt
    buffer_load_dwordx4 a[76:79], v2, s[4:7], s48 offen offset:512 nt
    buffer_load_dwordx4 a[80:83], v1, s[4:7], s48 offen offset:1024 nt
    buffer_load_dwordx4 a[84:87], v2, s[4:7], s48 offen offset:1024 nt
    buffer_load_dwordx4 a[88:91], v1, s[4:7], s48 offen offset:1536 nt
    buffer_load_dwordx4 a[92:95], v2, s[4:7], s48 offen offset:1536 nt
    s_xor_b32 s48, s49, 0x30000
    buffer_load_dwordx4 a[96:99], v1, s[4:7], s48 offen offset:0 nt
    buffer_load_dwordx4 a[100:103], v2, s[4:7], s48 offen offset:0 nt
    buffer_load_dwordx4 a[104:107], v1, s[4:7], s48 offen offset:512 nt
    buffer_load_dwordx4 a[108:111], v2, s[4:7], s48 offen offset:512 nt
    buffer_load_dwordx4 a[112:115], v1, s[4:7], s48 offen offset:1024 nt
    buffer_load_dwordx4 a[116:119], v2, s[4:7], s48 offen offset:1024 nt
    buffer_load_dwordx4 a[120:123], v1, s[4:7], s48 offen offset:1536 nt
    buffer_load_dwordx4 a[124:127], v2, s[4:7], s48 offen offset:1536 nt
    s_mov_b32 s8, s20
    s_mov_b32 s9, s21
    s_mov_b32 s10, 0x10000000
    s_mov_b32 s11, 0x00020000
    s_mov_b32 s47, 0x3db8aa3b
    v_bfe_u32 v9, v0, 1, 2
    v_lshlrev_b32 v9, 2, v9
    v_bfe_u32 v11, v0, 0, 1
    v_lshlrev_b32 v11, 4, v11
    v_bfe_u32 v10, v0, 3, 1
    v_lshl_or_b32 v11, v10, 5, v11
    v_bfe_u32 v10, v0, 4, 2
    v_lshl_or_b32 v11, v10, 11, v11
    s_mov_b32 s48, 0x4210
    v_lshrrev_b32 v3, v9, s48
    v_and_b32 v3, 15, v3
    v_lshl_or_b32 v3, v3, 6, v11
    s_mov_b32 s48, 0x3765
    v_lshrrev_b32 v4, v9, s48
    v_and_b32 v4, 15, v4
    v_lshl_or_b32 v4, v4, 6, v11
    v_lshrrev_b32 v10, 2, v13
    v_and_b32 v9, 2, v0
    v_lshlrev_b32 v9, 3, v9
    v_mov_b32 v8, 0xffff
    v_lshlrev_b32 v9, v9, v8
    v_cmp_eq_u32 vcc, 0, v10
    s_nop 1
    v_cndmask_b32 v36, 0, v9, vcc
    v_cmp_eq_u32 vcc, 1, v10
    s_nop 1
    v_cndmask_b32 v37, 0, v9, vcc
    v_cmp_eq_u32 vcc, 2, v10
    s_nop 1
    v_cndmask_b32 v38, 0, v9, vcc
    v_cmp_eq_u32 vcc, 3, v10
    s_nop 1
    v_cndmask_b32 v39, 0, v9, vcc
    v_mov_b32 v7, 0xf149f2ca
    v_mov_b32 v8, 0
    v_mov_b32 v48, 0
    v_mov_b32 v49, 0
    v_mov_b32 v50, 0
    v_mov_b32 v51, 0
    v_mov_b32 v52, 0
    v_mov_b32 v53, 0
    v_mov_b32 v54, 0
    v_mov_b32 v55, 0
    s_lshl_b32 s52, s3, 9
    s_add_u32 s52, s52, 2048
    v_lshlrev_b32 v15, 3, v0
    v_add_u32 v15, s52, v15
    v_mov_b32 v17, 1
    v_mov_b32 v21, s49
    v_bfe_u32 v9, v0, 0, 5
    v_lshlrev_b32 v9, 16, v9
    v_xor_b32 v21, v21, v9
    v_bfe_u32 v9, v0, 5, 1
    v_lshlrev_b32 v9, 23, v9
    v_xor_b32 v21, v21, v9
    s_lshl_b32 s52, s3, 12
    s_add_u32 s52, s52, 8192
    v_and_b32 v24, 1, v0
    v_lshlrev_b32 v24, 5, v24
    v_lshl_add_u32 v24, v14, 3, v24
    v_add_u32 v24, s52, v24
    v_bfe_u32 v22, v0, 2, 1
    v_lshlrev_b32 v22, 5, v22
    v_lshl_add_u32 v22, v14, 3, v22
    v_bfe_u32 v23, v0, 3, 1
    v_lshl_add_u32 v22, v23, 2, v22
    v_add_u32 v22, s52, v22
    v_add_u32 v23, 1280, v22
    v_mov_b32 v72, 0
    v_mov_b32 v73, 0
    v_mov_b32 v74, 0
    v_mov_b32 v75, 0
    v_mov_b32 v76, 0
    v_mov_b32 v77, 0
    v_mov_b32 v78, 0
    v_mov_b32 v79, 0
    v_mov_b32 v80, 0
    v_mov_b32 v81, 0
    v_mov_b32 v82, 0
    v_mov_b32 v83, 0
    v_mov_b32 v84, 0
    v_mov_b32 v85, 0
    v_mov_b32 v86, 0
    v_mov_b32 v87, 0
    s_mov_b32 s44, 0x00ff00ff
    s_mov_b32 s45, 0x00ff00ff
    v_mov_b32 v20, 0
    s_lshl_b32 s55, s2, 7
    s_lshl_b32 s52, s3, 2
    s_add_u32 s55, s55, s52
    s_add_u32 s55, s55, 0x50000
    s_mov_b32 s42, 12
    s_mov_b32 s16, 0
    s_mov_b32 s17, 0
    s_mov_b32 s21, 0
    s_mov_b32 s23, 0
    s_mov_b32 s43, 0
    s_mov_b32 s46, 0
    s_mov_b32 s24, 0
    s_mov_b32 s25, 0
    s_mov_b32 s26, 0
    s_mov_b32 s27, 0
    s_mov_b32 s30, 0
    s_mov_b32 s31, 0
    s_mov_b32 s32, 0
    s_mov_b32 s33, 0
    s_mov_b32 s34, 0
    s_mov_b32 s35, 0
    s_mov_b32 s36, 0
    s_mov_b32 s37, 0
    s_mov_b32 s38, 0
    s_mov_b32 s39, 0
    s_mov_b32 s18, 0x7fffffff
    s_mov_b32 s19, 0x80000000
    s_mov_b32 s20, 109568
    s_mov_b32 s28, 8
    s_mov_b32 s40, 0xcccc0000
    s_mov_b32 s60, 0xcccc
    s_mov_b32 s41, 0xcccc0000
    s_mov_b32 s61, 0xcccc
    s_xor_b32 s48, s49, 0x40000
    s_waitcnt vmcnt(24)
    buffer_load_dwordx4 a[128:131], v1, s[4:7], s48 offen offset:0 nt
    buffer_load_dwordx4 a[132:135], v2, s[4:7], s48 offen offset:0 nt
    buffer_load_dwordx4 a[136:139], v1, s[4:7], s48 offen offset:512 nt
    buffer_load_dwordx4 a[140:143], v2, s[4:7], s48 offen offset:512 nt
    buffer_load_dwordx4 a[144:147], v1, s[4:7], s48 offen offset:1024 nt
    buffer_load_dwordx4 a[148:151], v2, s[4:7], s48 offen offset:1024 nt
    buffer_load_dwordx4 a[152:155], v1, s[4:7], s48 offen offset:1536 nt
    buffer_load_dwordx4 a[156:159], v2, s[4:7], s48 offen offset:1536 nt
    s_xor_b32 s48, s49, 0x50000
    s_waitcnt vmcnt(24)
    buffer_load_dwordx4 a[160:163], v1, s[4:7], s48 offen offset:0 nt
    buffer_load_dwordx4 a[164:167], v2, s[4:7], s48 offen offset:0 nt
    buffer_load_dwordx4 a[168:171], v1, s[4:7], s48 offen offset:512 nt
    buffer_load_dwordx4 a[172:175], v2, s[4:7], s48 offen offset:512 nt
    buffer_load_dwordx4 a[176:179], v1, s[4:7], s48 offen offset:1024 nt
    buffer_load_dwordx4 a[180:183], v2, s[4:7], s48 offen offset:1024 nt
    buffer_load_dwordx4 a[184:187], v1, s[4:7], s48 offen offset:1536 nt
    buffer_load_dwordx4 a[188:191], v2, s[4:7], s48 offen offset:1536 nt
    s_xor_b32 s48, s49, 0x60000
    s_waitcnt vmcnt(24)
    buffer_load_dwordx4 a[192:195], v1, s[4:7], s48 offen offset:0 nt
    buffer_load_dwordx4 a[196:199], v2, s[4:7], s48 offen offset:0 nt
    buffer_load_dwordx4 a[200:203], v1, s[4:7], s48 offen offset:512 nt
    buffer_load_dwordx4 a[204:207], v2, s[4:7], s48 offen offset:512 nt
    buffer_load_dwordx4 a[208:211], v1, s[4:7], s48 offen offset:1024 nt
    buffer_load_dwordx4 a[212:215], v2, s[4:7], s48 offen offset:1024 nt
    buffer_load_dwordx4 a[216:219], v1, s[4:7], s48 offen offset:1536 nt
    buffer_load_dwordx4 a[220:223], v2, s[4:7], s48 offen offset:1536 nt
    s_xor_b32 s48, s49, 0x70000
    s_waitcnt vmcnt(24)
    buffer_load_dwordx4 a[224:227], v1, s[4:7], s48 offen offset:0 nt
    buffer_load_dwordx4 a[228:231], v2, s[4:7], s48 offen offset:0 nt
    buffer_load_dwordx4 a[232:235], v1, s[4:7], s48 offen offset:512 nt
    buffer_load_dwordx4 a[236:239], v2, s[4:7], s48 offen offset:512 nt
    buffer_load_dwordx4 a[240:243], v1, s[4:7], s48 offen offset:1024 nt
    buffer_load_dwordx4 a[244:247], v2, s[4:7], s48 offen offset:1024 nt
    buffer_load_dwordx4 a[248:251], v1, s[4:7], s48 offen offset:1536 nt
    buffer_load_dwordx4 a[252:255], v2, s[4:7], s48 offen offset:1536 nt
    s_xor_b32 s48, s49, 0x80000
    s_waitcnt vmcnt(24)
    buffer_load_dwordx4 v[88:91], v1, s[4:7], s48 offen offset:0 nt
    buffer_load_dwordx4 v[92:95], v2, s[4:7], s48 offen offset:0 nt
    buffer_load_dwordx4 v[96:99], v1, s[4:7], s48 offen offset:512 nt
    buffer_load_dwordx4 v[100:103], v2, s[4:7], s48 offen offset:512 nt
    buffer_load_dwordx4 v[104:107], v1, s[4:7], s48 offen offset:1024 nt
    buffer_load_dwordx4 v[108:111], v2, s[4:7], s48 offen offset:1024 nt
    buffer_load_dwordx4 v[112:115], v1, s[4:7], s48 offen offset:1536 nt
    buffer_load_dwordx4 v[116:119], v2, s[4:7], s48 offen offset:1536 nt
    s_xor_b32 s48, s49, 0x90000
    s_waitcnt vmcnt(24)
    buffer_load_dwordx4 v[120:123], v1, s[4:7], s48 offen offset:0 nt
    buffer_load_dwordx4 v[124:127], v2, s[4:7], s48 offen offset:0 nt
    buffer_load_dwordx4 v[128:131], v1, s[4:7], s48 offen offset:512 nt
    buffer_load_dwordx4 v[132:135], v2, s[4:7], s48 offen offset:512 nt
    buffer_load_dwordx4 v[136:139], v1, s[4:7], s48 offen offset:1024 nt
    buffer_load_dwordx4 v[140:143], v2, s[4:7], s48 offen offset:1024 nt
    buffer_load_dwordx4 v[144:147], v1, s[4:7], s48 offen offset:1536 nt
    buffer_load_dwordx4 v[148:151], v2, s[4:7], s48 offen offset:1536 nt
    s_xor_b32 s48, s49, 0xa0000
    s_waitcnt vmcnt(24)
    buffer_load_dwordx4 v[152:155], v1, s[4:7], s48 offen offset:0 nt
    buffer_load_dwordx4 v[156:159], v2, s[4:7], s48 offen offset:0 nt
    buffer_load_dwordx4 v[160:163], v1, s[4:7], s48 offen offset:512 nt
    buffer_load_dwordx4 v[164:167], v2, s[4:7], s48 offen offset:512 nt
    buffer_load_dwordx4 v[168:171], v1, s[4:7], s48 offen offset:1024 nt
    buffer_load_dwordx4 v[172:175], v2, s[4:7], s48 offen offset:1024 nt
    buffer_load_dwordx4 v[176:179], v1, s[4:7], s48 offen offset:1536 nt
    buffer_load_dwordx4 v[180:183], v2, s[4:7], s48 offen offset:1536 nt
    s_xor_b32 s48, s49, 0xb0000
    s_waitcnt vmcnt(24)
    buffer_load_dwordx4 v[184:187], v1, s[4:7], s48 offen offset:0 nt
    buffer_load_dwordx4 v[188:191], v2, s[4:7], s48 offen offset:0 nt
    buffer_load_dwordx4 v[192:195], v1, s[4:7], s48 offen offset:512 nt
    buffer_load_dwordx4 v[196:199], v2, s[4:7], s48 offen offset:512 nt
    buffer_load_dwordx4 v[200:203], v1, s[4:7], s48 offen offset:1024 nt
    buffer_load_dwordx4 v[204:207], v2, s[4:7], s48 offen offset:1024 nt
    buffer_load_dwordx4 v[208:211], v1, s[4:7], s48 offen offset:1536 nt
    buffer_load_dwordx4 v[212:215], v2, s[4:7], s48 offen offset:1536 nt
    v_bfe_u32 v10, v0, 2, 1
    v_lshlrev_b32 v10, 9, v10
    s_movk_i32 s48, 0x1ff
    v_and_or_b32 v9, v1, s48, v10
    v_and_or_b32 v11, v2, s48, v10
    v_mov_b32 v10, 0
    s_mov_b64 exec, s[44:45]
    s_barrier
    ds_read_b128 v[72:75], v9
    ds_read_b128 v[76:79], v11
    s_not_b64 exec, exec
    ds_read_b128 v[80:83], v9
    ds_read_b128 v[84:87], v11
    s_mov_b64 exec, -1
    ds_read_b32 v10, v10 offset:1024
    s_waitcnt lgkmcnt(0)
    v_readfirstlane_b32 s88, v10
    v_readlane_b32 s53, v21, s42
    s_lshr_b32 s22, s20, 8
    s_add_u32 s22, s22, s88
    s_add_u32 s20, s20, 13696
    s_sub_u32 s21, s21, s24
    s_add_u32 s23, s23, s24
    s_add_u32 s22, s22, s23
    s_ashr_i32 s29, s16, 8
    s_add_u32 s16, s16, s17
    s_sub_u32 s29, s21, s29
    s_waitcnt vmcnt(24)
    s_memrealtime s[58:59]
    v_mfma_f32_16x16x32_bf16 v[40:43], v[88:91], v[72:75], 0
    v_mfma_f32_16x16x32_bf16 v[44:47], v[96:99], v[72:75], 0
    v_mfma_f32_16x16x32_bf16 v[40:43], v[92:95], v[76:79], v[40:43]
    v_mfma_f32_16x16x32_bf16 v[44:47], v[100:103], v[76:79], v[44:47]
    v_mfma_f32_16x16x32_bf16 v[40:43], v[104:107], v[80:83], v[40:43]
    v_mfma_f32_16x16x32_bf16 v[44:47], v[112:115], v[80:83], v[44:47]
    v_mfma_f32_16x16x32_bf16 v[40:43], v[108:111], v[84:87], v[40:43]
    v_mfma_f32_16x16x32_bf16 v[44:47], v[116:119], v[84:87], v[44:47]
    s_add_u32 s42, s42, 1
    s_waitcnt lgkmcnt(0)
    s_sub_u32 s22, s58, s22
    s_ashr_i32 s22, s22, 2
    s_add_u32 s23, s23, s22
    s_add_u32 s22, s23, s29
    s_cmp_gt_i32 s22, s18
    s_cselect_b64 s[30:31], s[40:41], 0
    s_cselect_b32 s24, -14, 0
    s_cmp_lt_i32 s22, s19
    s_cselect_b64 s[30:31], s[60:61], s[30:31]
    s_cselect_b32 s24, 25, s24
    v_cndmask_b32 v26, v1, v2, s[30:31]
    v_cndmask_b32 v27, v2, v1, s[30:31]
    s_add_u32 s21, s21, s24
    buffer_load_dwordx4 v[88:91], v26, s[4:7], s53 offen offset:0 nt
    buffer_load_dwordx4 v[92:95], v27, s[4:7], s53 offen offset:0 nt
    buffer_load_dwordx4 v[96:99], v26, s[4:7], s53 offen offset:512 nt
    buffer_load_dwordx4 v[100:103], v27, s[4:7], s53 offen offset:512 nt
    buffer_load_dwordx4 v[104:107], v26, s[4:7], s53 offen offset:1024 nt
    buffer_load_dwordx4 v[108:111], v27, s[4:7], s53 offen offset:1024 nt
    buffer_load_dwordx4 v[112:115], v26, s[4:7], s53 offen offset:1536 nt
    buffer_load_dwordx4 v[116:119], v27, s[4:7], s53 offen offset:1536 nt
    v_mov_b32_dpp v9, v40 quad_perm:[0,0,0,0] row_mask:0xf bank_mask:0xf
    v_mov_b32_dpp v10, v44 quad_perm:[0,0,0,0] row_mask:0xf bank_mask:0xf
    v_add_f32_dpp v9, v41, v9 quad_perm:[1,1,1,1] row_mask:0xf bank_mask:0xf
    v_add_f32_dpp v10, v45, v10 quad_perm:[1,1,1,1] row_mask:0xf bank_mask:0xf
    v_add_f32_dpp v9, v42, v9 quad_perm:[2,2,2,2] row_mask:0xf bank_mask:0xf
    v_add_f32_dpp v10, v46, v10 quad_perm:[2,2,2,2] row_mask:0xf bank_mask:0xf
    v_add_f32_dpp v9, v43, v9 quad_perm:[3,3,3,3] row_mask:0xf bank_mask:0xf
    v_add_f32_dpp v10, v47, v10 quad_perm:[3,3,3,3] row_mask:0xf bank_mask:0xf
    v_cvt_pk_bf16_f32 v30, v9, v10
    v_max3_f32 v7, v9, v10, v7
    ds_write_b32 v22, v30 offset:512
    v_mov_b32 v28, s28
    v_mov_b32 v29, s23
    ds_write_b64 v15, v[28:29]
    s_add_u32 s28, s28, 1
    s_mul_i32 s89, s88, 0x9e3779b1
    s_add_u32 s89, s89, 0x7f4a7c15
    v_mov_b32 v19, s88
    v_readlane_b32 s53, v21, s42
    s_lshr_b32 s22, s20, 8
    s_add_u32 s22, s22, s88
    s_add_u32 s20, s20, 13696
    s_sub_u32 s21, s21, s25
    s_add_u32 s23, s23, s25
    s_add_u32 s22, s22, s23
    s_ashr_i32 s29, s16, 8
    s_add_u32 s16, s16, s17
    s_sub_u32 s29, s21, s29
    s_waitcnt vmcnt(24)
    s_memrealtime s[58:59]
    v_mfma_f32_16x16x32_bf16 v[40:43], v[120:123], v[72:75], 0
    v_mfma_f32_16x16x32_bf16 v[44:47], v[128:131], v[72:75], 0
    v_mfma_f32_16x16x32_bf16 v[40:43], v[124:127], v[76:79], v[40:43]
    v_mfma_f32_16x16x32_bf16 v[44:47], v[132:135], v[76:79], v[44:47]
    v_mfma_f32_16x16x32_bf16 v[40:43], v[136:139], v[80:83], v[40:43]
    v_mfma_f32_16x16x32_bf16 v[44:47], v[144:147], v[80:83], v[44:47]
    v_mfma_f32_16x16x32_bf16 v[40:43], v[140:143], v[84:87], v[40:43]
    v_mfma_f32_16x16x32_bf16 v[44:47], v[148:151], v[84:87], v[44:47]
    s_add_u32 s42, s42, 1
    s_waitcnt lgkmcnt(0)
    s_sub_u32 s22, s58, s22
    s_ashr_i32 s22, s22, 2
    s_add_u32 s23, s23, s22
    s_add_u32 s22, s23, s29
    s_cmp_gt_i32 s22, s18
    s_cselect_b64 s[32:33], s[40:41], 0
    s_cselect_b32 s25, -14, 0
    s_cmp_lt_i32 s22, s19
    s_cselect_b64 s[32:33], s[60:61], s[32:33]
    s_cselect_b32 s25, 25, s25
    v_cndmask_b32 v26, v1, v2, s[32:33]
    v_cndmask_b32 v27, v2, v1, s[32:33]
    s_add_u32 s21, s21, s25
    buffer_load_dwordx4 v[120:123], v26, s[4:7], s53 offen offset:0 nt
    buffer_load_dwordx4 v[124:127], v27, s[4:7], s53 offen offset:0 nt
    buffer_load_dwordx4 v[128:131], v26, s[4:7], s53 offen offset:512 nt
    buffer_load_dwordx4 v[132:135], v27, s[4:7], s53 offen offset:512 nt
    buffer_load_dwordx4 v[136:139], v26, s[4:7], s53 offen offset:1024 nt
    buffer_load_dwordx4 v[140:143], v27, s[4:7], s53 offen offset:1024 nt
    buffer_load_dwordx4 v[144:147], v26, s[4:7], s53 offen offset:1536 nt
    buffer_load_dwordx4 v[148:151], v27, s[4:7], s53 offen offset:1536 nt
    v_mov_b32_dpp v9, v40 quad_perm:[0,0,0,0] row_mask:0xf bank_mask:0xf
    v_mov_b32_dpp v10, v44 quad_perm:[0,0,0,0] row_mask:0xf bank_mask:0xf
    v_add_f32_dpp v9, v41, v9 quad_perm:[1,1,1,1] row_mask:0xf bank_mask:0xf
    v_add_f32_dpp v10, v45, v10 quad_perm:[1,1,1,1] row_mask:0xf bank_mask:0xf
    v_add_f32_dpp v9, v42, v9 quad_perm:[2,2,2,2] row_mask:0xf bank_mask:0xf
    v_add_f32_dpp v10, v46, v10 quad_perm:[2,2,2,2] row_mask:0xf bank_mask:0xf
    v_add_f32_dpp v9, v43, v9 quad_perm:[3,3,3,3] row_mask:0xf bank_mask:0xf
    v_add_f32_dpp v10, v47, v10 quad_perm:[3,3,3,3] row_mask:0xf bank_mask:0xf
    v_cvt_pk_bf16_f32 v30, v9, v10
    v_max3_f32 v7, v9, v10, v7
    ds_write_b32 v22, v30 offset:576
    v_mov_b32 v28, s28
    v_mov_b32 v29, s23
    ds_write_b64 v15, v[28:29]
    s_add_u32 s28, s28, 1
    v_readlane_b32 s53, v21, s42
    s_lshr_b32 s22, s20, 8
    s_add_u32 s22, s22, s88
    s_add_u32 s20, s20, 13696
    s_sub_u32 s21, s21, s26
    s_add_u32 s23, s23, s26
    s_add_u32 s22, s22, s23
    s_ashr_i32 s29, s16, 8
    s_add_u32 s16, s16, s17
    s_sub_u32 s29, s21, s29
    s_waitcnt vmcnt(24)
    s_memrealtime s[58:59]
    v_mfma_f32_16x16x32_bf16 v[40:43], v[152:155], v[72:75], 0
    v_mfma_f32_16x16x32_bf16 v[44:47], v[160:163], v[72:75], 0
    v_mfma_f32_16x16x32_bf16 v[40:43], v[156:159], v[76:79], v[40:43]
    v_mfma_f32_16x16x32_bf16 v[44:47], v[164:167], v[76:79], v[44:47]
    v_mfma_f32_16x16x32_bf16 v[40:43], v[168:171], v[80:83], v[40:43]
    v_mfma_f32_16x16x32_bf16 v[44:47], v[176:179], v[80:83], v[44:47]
    v_mfma_f32_16x16x32_bf16 v[40:43], v[172:175], v[84:87], v[40:43]
    v_mfma_f32_16x16x32_bf16 v[44:47], v[180:183], v[84:87], v[44:47]
    s_add_u32 s42, s42, 1
    s_waitcnt lgkmcnt(0)
    s_sub_u32 s22, s58, s22
    s_ashr_i32 s22, s22, 2
    s_add_u32 s23, s23, s22
    s_add_u32 s22, s23, s29
    s_cmp_gt_i32 s22, s18
    s_cselect_b64 s[34:35], s[40:41], 0
    s_cselect_b32 s26, -14, 0
    s_cmp_lt_i32 s22, s19
    s_cselect_b64 s[34:35], s[60:61], s[34:35]
    s_cselect_b32 s26, 25, s26
    v_cndmask_b32 v26, v1, v2, s[34:35]
    v_cndmask_b32 v27, v2, v1, s[34:35]
    s_add_u32 s21, s21, s26
    buffer_load_dwordx4 v[152:155], v26, s[4:7], s53 offen offset:0 nt
    buffer_load_dwordx4 v[156:159], v27, s[4:7], s53 offen offset:0 nt
    buffer_load_dwordx4 v[160:163], v26, s[4:7], s53 offen offset:512 nt
    buffer_load_dwordx4 v[164:167], v27, s[4:7], s53 offen offset:512 nt
    buffer_load_dwordx4 v[168:171], v26, s[4:7], s53 offen offset:1024 nt
    buffer_load_dwordx4 v[172:175], v27, s[4:7], s53 offen offset:1024 nt
    buffer_load_dwordx4 v[176:179], v26, s[4:7], s53 offen offset:1536 nt
    buffer_load_dwordx4 v[180:183], v27, s[4:7], s53 offen offset:1536 nt
    v_mov_b32_dpp v9, v40 quad_perm:[0,0,0,0] row_mask:0xf bank_mask:0xf
    v_mov_b32_dpp v10, v44 quad_perm:[0,0,0,0] row_mask:0xf bank_mask:0xf
    v_add_f32_dpp v9, v41, v9 quad_perm:[1,1,1,1] row_mask:0xf bank_mask:0xf
    v_add_f32_dpp v10, v45, v10 quad_perm:[1,1,1,1] row_mask:0xf bank_mask:0xf
    v_add_f32_dpp v9, v42, v9 quad_perm:[2,2,2,2] row_mask:0xf bank_mask:0xf
    v_add_f32_dpp v10, v46, v10 quad_perm:[2,2,2,2] row_mask:0xf bank_mask:0xf
    v_add_f32_dpp v9, v43, v9 quad_perm:[3,3,3,3] row_mask:0xf bank_mask:0xf
    v_add_f32_dpp v10, v47, v10 quad_perm:[3,3,3,3] row_mask:0xf bank_mask:0xf
    v_cvt_pk_bf16_f32 v30, v9, v10
    v_max3_f32 v7, v9, v10, v7
    ds_write_b32 v22, v30 offset:640
    v_mov_b32 v28, s28
    v_mov_b32 v29, s23
    ds_write_b64 v15, v[28:29]
    s_add_u32 s28, s28, 1
    v_readlane_b32 s53, v21, s42
    s_lshr_b32 s22, s20, 8
    s_add_u32 s22, s22, s88
    s_add_u32 s20, s20, 13696
    s_sub_u32 s21, s21, s27
    s_add_u32 s23, s23, s27
    s_add_u32 s22, s22, s23
    s_ashr_i32 s29, s16, 8
    s_add_u32 s16, s16, s17
    s_sub_u32 s29, s21, s29
    s_waitcnt vmcnt(24)
    s_memrealtime s[58:59]
    v_mfma_f32_16x16x32_bf16 v[40:43], v[184:187], v[72:75], 0
    v_mfma_f32_16x16x32_bf16 v[44:47], v[192:195], v[72:75], 0
    v_mfma_f32_16x16x32_bf16 v[40:43], v[188:191], v[76:79], v[40:43]
    v_mfma_f32_16x16x32_bf16 v[44:47], v[196:199], v[76:79], v[44:47]
    v_mfma_f32_16x16x32_bf16 v[40:43], v[200:203], v[80:83], v[40:43]
    v_mfma_f32_16x16x32_bf16 v[44:47], v[208:211], v[80:83], v[44:47]
    v_mfma_f32_16x16x32_bf16 v[40:43], v[204:207], v[84:87], v[40:43]
    v_mfma_f32_16x16x32_bf16 v[44:47], v[212:215], v[84:87], v[44:47]
    s_add_u32 s42, s42, 1
    s_waitcnt lgkmcnt(0)
    s_sub_u32 s22, s58, s22
    s_ashr_i32 s22, s22, 2
    s_add_u32 s23, s23, s22
    s_add_u32 s22, s23, s29
    s_cmp_gt_i32 s22, s18
    s_cselect_b64 s[36:37], s[40:41], 0
    s_cselect_b32 s27, -14, 0
    s_cmp_lt_i32 s22, s19
    s_cselect_b64 s[36:37], s[60:61], s[36:37]
    s_cselect_b32 s27, 25, s27
    v_cndmask_b32 v26, v1, v2, s[36:37]
    v_cndmask_b32 v27, v2, v1, s[36:37]
    s_add_u32 s21, s21, s27
    buffer_load_dwordx4 v[184:187], v26, s[4:7], s53 offen offset:0 nt
    buffer_load_dwordx4 v[188:191], v27, s[4:7], s53 offen offset:0 nt
    buffer_load_dwordx4 v[192:195], v26, s[4:7], s53 offen offset:512 nt
    buffer_load_dwordx4 v[196:199], v27, s[4:7], s53 offen offset:512 nt
    buffer_load_dwordx4 v[200:203], v26, s[4:7], s53 offen offset:1024 nt
    buffer_load_dwordx4 v[204:207], v27, s[4:7], s53 offen offset:1024 nt
    buffer_load_dwordx4 v[208:211], v26, s[4:7], s53 offen offset:1536 nt
    buffer_load_dwordx4 v[212:215], v27, s[4:7], s53 offen offset:1536 nt
    v_mov_b32_dpp v9, v40 quad_perm:[0,0,0,0] row_mask:0xf bank_mask:0xf
    v_mov_b32_dpp v10, v44 quad_perm:[0,0,0,0] row_mask:0xf bank_mask:0xf
    v_add_f32_dpp v9, v41, v9 quad_perm:[1,1,1,1] row_mask:0xf bank_mask:0xf
    v_add_f32_dpp v10, v45, v10 quad_perm:[1,1,1,1] row_mask:0xf bank_mask:0xf
    v_add_f32_dpp v9, v42, v9 quad_perm:[2,2,2,2] row_mask:0xf bank_mask:0xf
    v_add_f32_dpp v10, v46, v10 quad_perm:[2,2,2,2] row_mask:0xf bank_mask:0xf
    v_add_f32_dpp v9, v43, v9 quad_perm:[3,3,3,3] row_mask:0xf bank_mask:0xf
    v_add_f32_dpp v10, v47, v10 quad_perm:[3,3,3,3] row_mask:0xf bank_mask:0xf
    v_cvt_pk_bf16_f32 v30, v9, v10
    v_max3_f32 v7, v9, v10, v7
    ds_write_b32 v22, v30 offset:704
    v_mov_b32 v28, s28
    v_mov_b32 v29, s23
    ds_write_b64 v15, v[28:29]
    s_add_u32 s28, s28, 1
    v_mfma_f32_16x16x32_bf16 v[40:43], a[0:3], v[72:75], 0
    v_mfma_f32_16x16x32_bf16 v[44:47], a[8:11], v[72:75], 0
    v_mfma_f32_16x16x32_bf16 v[40:43], a[4:7], v[76:79], v[40:43]
    v_mfma_f32_16x16x32_bf16 v[44:47], a[12:15], v[76:79], v[44:47]
    v_mfma_f32_16x16x32_bf16 v[40:43], a[16:19], v[80:83], v[40:43]
    v_mfma_f32_16x16x32_bf16 v[44:47], a[24:27], v[80:83], v[44:47]
    v_mfma_f32_16x16x32_bf16 v[40:43], a[20:23], v[84:87], v[40:43]
    v_mfma_f32_16x16x32_bf16 v[44:47], a[28:31], v[84:87], v[44:47]
    s_nop 7
    v_mov_b32_dpp v9, v40 quad_perm:[0,0,0,0] row_mask:0xf bank_mask:0xf
    v_mov_b32_dpp v10, v44 quad_perm:[0,0,0,0] row_mask:0xf bank_mask:0xf
    v_add_f32_dpp v9, v41, v9 quad_perm:[1,1,1,1] row_mask:0xf bank_mask:0xf
    v_add_f32_dpp v10, v45, v10 quad_perm:[1,1,1,1] row_mask:0xf bank_mask:0xf
    v_add_f32_dpp v9, v42, v9 quad_perm:[2,2,2,2] row_mask:0xf bank_mask:0xf
    v_add_f32_dpp v10, v46, v10 quad_perm:[2,2,2,2] row_mask:0xf bank_mask:0xf
    v_add_f32_dpp v9, v43, v9 quad_perm:[3,3,3,3] row_mask:0xf bank_mask:0xf
    v_add_f32_dpp v10, v47, v10 quad_perm:[3,3,3,3] row_mask:0xf bank_mask:0xf
    v_cvt_pk_bf16_f32 v30, v9, v10
    v_max3_f32 v7, v9, v10, v7
    ds_write_b32 v22, v30 offset:0
    v_mfma_f32_16x16x32_bf16 v[40:43], a[32:35], v[72:75], 0
    v_mfma_f32_16x16x32_bf16 v[44:47], a[40:43], v[72:75], 0
    v_mfma_f32_16x16x32_bf16 v[40:43], a[36:39], v[76:79], v[40:43]
    v_mfma_f32_16x16x32_bf16 v[44:47], a[44:47], v[76:79], v[44:47]
    v_mfma_f32_16x16x32_bf16 v[40:43], a[48:51], v[80:83], v[40:43]
    v_mfma_f32_16x16x32_bf16 v[44:47], a[56:59], v[80:83], v[44:47]
    v_mfma_f32_16x16x32_bf16 v[40:43], a[52:55], v[84:87], v[40:43]
    v_mfma_f32_16x16x32_bf16 v[44:47], a[60:63], v[84:87], v[44:47]
    s_nop 7
    v_mov_b32_dpp v9, v40 quad_perm:[0,0,0,0] row_mask:0xf bank_mask:0xf
    v_mov_b32_dpp v10, v44 quad_perm:[0,0,0,0] row_mask:0xf bank_mask:0xf
    v_add_f32_dpp v9, v41, v9 quad_perm:[1,1,1,1] row_mask:0xf bank_mask:0xf
    v_add_f32_dpp v10, v45, v10 quad_perm:[1,1,1,1] row_mask:0xf bank_mask:0xf
    v_add_f32_dpp v9, v42, v9 quad_perm:[2,2,2,2] row_mask:0xf bank_mask:0xf
    v_add_f32_dpp v10, v46, v10 quad_perm:[2,2,2,2] row_mask:0xf bank_mask:0xf
    v_add_f32_dpp v9, v43, v9 quad_perm:[3,3,3,3] row_mask:0xf bank_mask:0xf
    v_add_f32_dpp v10, v47, v10 quad_perm:[3,3,3,3] row_mask:0xf bank_mask:0xf
    v_cvt_pk_bf16_f32 v30, v9, v10
    v_max3_f32 v7, v9, v10, v7
    ds_write_b32 v22, v30 offset:64
    v_readlane_b32 s53, v21, s42
    s_lshr_b32 s22, s20, 8
    s_add_u32 s22, s22, s88
    s_add_u32 s20, s20, 13696
    s_sub_u32 s21, s21, s24
    s_add_u32 s23, s23, s24
    s_add_u32 s22, s22, s23
    s_ashr_i32 s29, s16, 8
    s_add_u32 s16, s16, s17
    s_sub_u32 s29, s21, s29
    s_waitcnt vmcnt(24)
    s_memrealtime s[58:59]
    v_mfma_f32_16x16x32_bf16 v[40:43], v[88:91], v[72:75], 0
    v_mfma_f32_16x16x32_bf16 v[44:47], v[96:99], v[72:75], 0
    v_mfma_f32_16x16x32_bf16 v[40:43], v[92:95], v[76:79], v[40:43]
    v_mfma_f32_16x16x32_bf16 v[44:47], v[100:103], v[76:79], v[44:47]
    v_mfma_f32_16x16x32_bf16 v[40:43], v[104:107], v[80:83], v[40:43]
    v_mfma_f32_16x16x32_bf16 v[44:47], v[112:115], v[80:83], v[44:47]
    v_mfma_f32_16x16x32_bf16 v[40:43], v[108:111], v[84:87], v[40:43]
    v_mfma_f32_16x16x32_bf16 v[44:47], v[116:119], v[84:87], v[44:47]
    s_add_u32 s42, s42, 1
    s_waitcnt lgkmcnt(0)
    s_sub_u32 s22, s58, s22
    s_ashr_i32 s22, s22, 2
    s_add_u32 s23, s23, s22
    s_add_u32 s22, s23, s29
    s_cmp_gt_i32 s22, s18
    s_cselect_b64 s[30:31], s[40:41], 0
    s_cselect_b32 s24, -14, 0
    s_cmp_lt_i32 s22, s19
    s_cselect_b64 s[30:31], s[60:61], s[30:31]
    s_cselect_b32 s24, 25, s24
    v_cndmask_b32 v26, v1, v2, s[30:31]
    v_cndmask_b32 v27, v2, v1, s[30:31]
    s_add_u32 s21, s21, s24
    buffer_load_dwordx4 v[88:91], v26, s[4:7], s53 offen offset:0 nt
    buffer_load_dwordx4 v[92:95], v27, s[4:7], s53 offen offset:0 nt
    buffer_load_dwordx4 v[96:99], v26, s[4:7], s53 offen offset:512 nt
    buffer_load_dwordx4 v[100:103], v27, s[4:7], s53 offen offset:512 nt
    buffer_load_dwordx4 v[104:107], v26, s[4:7], s53 offen offset:1024 nt
    buffer_load_dwordx4 v[108:111], v27, s[4:7], s53 offen offset:1024 nt
    buffer_load_dwordx4 v[112:115], v26, s[4:7], s53 offen offset:1536 nt
    buffer_load_dwordx4 v[116:119], v27, s[4:7], s53 offen offset:1536 nt
    v_mov_b32_dpp v9, v40 quad_perm:[0,0,0,0] row_mask:0xf bank_mask:0xf
    v_mov_b32_dpp v10, v44 quad_perm:[0,0,0,0] row_mask:0xf bank_mask:0xf
    v_add_f32_dpp v9, v41, v9 quad_perm:[1,1,1,1] row_mask:0xf bank_mask:0xf
    v_add_f32_dpp v10, v45, v10 quad_perm:[1,1,1,1] row_mask:0xf bank_mask:0xf
    v_add_f32_dpp v9, v42, v9 quad_perm:[2,2,2,2] row_mask:0xf bank_mask:0xf
    v_add_f32_dpp v10, v46, v10 quad_perm:[2,2,2,2] row_mask:0xf bank_mask:0xf
    v_add_f32_dpp v9, v43, v9 quad_perm:[3,3,3,3] row_mask:0xf bank_mask:0xf
    v_add_f32_dpp v10, v47, v10 quad_perm:[3,3,3,3] row_mask:0xf bank_mask:0xf
    v_cvt_pk_bf16_f32 v30, v9, v10
    v_max3_f32 v7, v9, v10, v7
    ds_write_b32 v22, v30 offset:768
    v_mov_b32 v28, s28
    v_mov_b32 v29, s23
    ds_write_b64 v15, v[28:29]
    s_add_u32 s28, s28, 1
    v_mfma_f32_16x16x32_bf16 v[40:43], a[64:67], v[72:75], 0
    v_mfma_f32_16x16x32_bf16 v[44:47], a[72:75], v[72:75], 0
    v_mfma_f32_16x16x32_bf16 v[40:43], a[68:71], v[76:79], v[40:43]
    v_mfma_f32_16x16x32_bf16 v[44:47], a[76:79], v[76:79], v[44:47]
    v_mfma_f32_16x16x32_bf16 v[40:43], a[80:83], v[80:83], v[40:43]
    v_mfma_f32_16x16x32_bf16 v[44:47], a[88:91], v[80:83], v[44:47]
    v_mfma_f32_16x16x32_bf16 v[40:43], a[84:87], v[84:87], v[40:43]
    v_mfma_f32_16x16x32_bf16 v[44:47], a[92:95], v[84:87], v[44:47]
    s_nop 7
    v_mov_b32_dpp v9, v40 quad_perm:[0,0,0,0] row_mask:0xf bank_mask:0xf
    v_mov_b32_dpp v10, v44 quad_perm:[0,0,0,0] row_mask:0xf bank_mask:0xf
    v_add_f32_dpp v9, v41, v9 quad_perm:[1,1,1,1] row_mask:0xf bank_mask:0xf
    v_add_f32_dpp v10, v45, v10 quad_perm:[1,1,1,1] row_mask:0xf bank_mask:0xf
    v_add_f32_dpp v9, v42, v9 quad_perm:[2,2,2,2] row_mask:0xf bank_mask:0xf
    v_add_f32_dpp v10, v46, v10 quad_perm:[2,2,2,2] row_mask:0xf bank_mask:0xf
    v_add_f32_dpp v9, v43, v9 quad_perm:[3,3,3,3] row_mask:0xf bank_mask:0xf
    v_add_f32_dpp v10, v47, v10 quad_perm:[3,3,3,3] row_mask:0xf bank_mask:0xf
    v_cvt_pk_bf16_f32 v30, v9, v10
    v_max3_f32 v7, v9, v10, v7
    ds_write_b32 v22, v30 offset:128
    v_readlane_b32 s53, v21, s42
    s_lshr_b32 s22, s20, 8
    s_add_u32 s22, s22, s88
    s_add_u32 s20, s20, 13696
    s_sub_u32 s21, s21, s25
    s_add_u32 s23, s23, s25
    s_add_u32 s22, s22, s23
    s_ashr_i32 s29, s16, 8
    s_add_u32 s16, s16, s17
    s_sub_u32 s29, s21, s29
    s_waitcnt vmcnt(24)
    s_memrealtime s[58:59]
    v_mfma_f32_16x16x32_bf16 v[40:43], v[120:123], v[72:75], 0
    v_mfma_f32_16x16x32_bf16 v[44:47], v[128:131], v[72:75], 0
    v_mfma_f32_16x16x32_bf16 v[40:43], v[124:127], v[76:79], v[40:43]
    v_mfma_f32_16x16x32_bf16 v[44:47], v[132:135], v[76:79], v[44:47]
    v_mfma_f32_16x16x32_bf16 v[40:43], v[136:139], v[80:83], v[40:43]
    v_mfma_f32_16x16x32_bf16 v[44:47], v[144:147], v[80:83], v[44:47]
    v_mfma_f32_16x16x32_bf16 v[40:43], v[140:143], v[84:87], v[40:43]
    v_mfma_f32_16x16x32_bf16 v[44:47], v[148:151], v[84:87], v[44:47]
    s_add_u32 s42, s42, 1
    s_waitcnt lgkmcnt(0)
    s_sub_u32 s22, s58, s22
    s_ashr_i32 s22, s22, 2
    s_add_u32 s23, s23, s22
    s_add_u32 s22, s23, s29
    s_cmp_gt_i32 s22, s18
    s_cselect_b64 s[32:33], s[40:41], 0
    s_cselect_b32 s25, -14, 0
    s_cmp_lt_i32 s22, s19
    s_cselect_b64 s[32:33], s[60:61], s[32:33]
    s_cselect_b32 s25, 25, s25
    v_cndmask_b32 v26, v1, v2, s[32:33]
    v_cndmask_b32 v27, v2, v1, s[32:33]
    s_add_u32 s21, s21, s25
    buffer_load_dwordx4 v[120:123], v26, s[4:7], s53 offen offset:0 nt
    buffer_load_dwordx4 v[124:127], v27, s[4:7], s53 offen offset:0 nt
    buffer_load_dwordx4 v[128:131], v26, s[4:7], s53 offen offset:512 nt
    buffer_load_dwordx4 v[132:135], v27, s[4:7], s53 offen offset:512 nt
    buffer_load_dwordx4 v[136:139], v26, s[4:7], s53 offen offset:1024 nt
    buffer_load_dwordx4 v[140:143], v27, s[4:7], s53 offen offset:1024 nt
    buffer_load_dwordx4 v[144:147], v26, s[4:7], s53 offen offset:1536 nt
    buffer_load_dwordx4 v[148:151], v27, s[4:7], s53 offen offset:1536 nt
    v_mov_b32_dpp v9, v40 quad_perm:[0,0,0,0] row_mask:0xf bank_mask:0xf
    v_mov_b32_dpp v10, v44 quad_perm:[0,0,0,0] row_mask:0xf bank_mask:0xf
    v_add_f32_dpp v9, v41, v9 quad_perm:[1,1,1,1] row_mask:0xf bank_mask:0xf
    v_add_f32_dpp v10, v45, v10 quad_perm:[1,1,1,1] row_mask:0xf bank_mask:0xf
    v_add_f32_dpp v9, v42, v9 quad_perm:[2,2,2,2] row_mask:0xf bank_mask:0xf
    v_add_f32_dpp v10, v46, v10 quad_perm:[2,2,2,2] row_mask:0xf bank_mask:0xf
    v_add_f32_dpp v9, v43, v9 quad_perm:[3,3,3,3] row_mask:0xf bank_mask:0xf
    v_add_f32_dpp v10, v47, v10 quad_perm:[3,3,3,3] row_mask:0xf bank_mask:0xf
    v_cvt_pk_bf16_f32 v30, v9, v10
    v_max3_f32 v7, v9, v10, v7
    ds_write_b32 v22, v30 offset:832
    v_mov_b32 v28, s28
    v_mov_b32 v29, s23
    ds_write_b64 v15, v[28:29]
    s_add_u32 s28, s28, 1
    v_mfma_f32_16x16x32_bf16 v[40:43], a[96:99], v[72:75], 0
    v_mfma_f32_16x16x32_bf16 v[44:47], a[104:107], v[72:75], 0
    v_mfma_f32_16x16x32_bf16 v[40:43], a[100:103], v[76:79], v[40:43]
    v_mfma_f32_16x16x32_bf16 v[44:47], a[108:111], v[76:79], v[44:47]
    v_mfma_f32_16x16x32_bf16 v[40:43], a[112:115], v[80:83], v[40:43]
    v_mfma_f32_16x16x32_bf16 v[44:47], a[120:123], v[80:83], v[44:47]
    v_mfma_f32_16x16x32_bf16 v[40:43], a[116:119], v[84:87], v[40:43]
    v_mfma_f32_16x16x32_bf16 v[44:47], a[124:127], v[84:87], v[44:47]
    s_nop 7
    v_mov_b32_dpp v9, v40 quad_perm:[0,0,0,0] row_mask:0xf bank_mask:0xf
    v_mov_b32_dpp v10, v44 quad_perm:[0,0,0,0] row_mask:0xf bank_mask:0xf
    v_add_f32_dpp v9, v41, v9 quad_perm:[1,1,1,1] row_mask:0xf bank_mask:0xf
    v_add_f32_dpp v10, v45, v10 quad_perm:[1,1,1,1] row_mask:0xf bank_mask:0xf
    v_add_f32_dpp v9, v42, v9 quad_perm:[2,2,2,2] row_mask:0xf bank_mask:0xf
    v_add_f32_dpp v10, v46, v10 quad_perm:[2,2,2,2] row_mask:0xf bank_mask:0xf
    v_add_f32_dpp v9, v43, v9 quad_perm:[3,3,3,3] row_mask:0xf bank_mask:0xf
    v_add_f32_dpp v10, v47, v10 quad_perm:[3,3,3,3] row_mask:0xf bank_mask:0xf
    v_cvt_pk_bf16_f32 v30, v9, v10
    v_max3_f32 v7, v9, v10, v7
    ds_write_b32 v22, v30 offset:192
    v_readlane_b32 s53, v21, s42
    s_lshr_b32 s22, s20, 8
    s_add_u32 s22, s22, s88
    s_add_u32 s20, s20, 13696
    s_sub_u32 s21, s21, s26
    s_add_u32 s23, s23, s26
    s_add_u32 s22, s22, s23
    s_ashr_i32 s29, s16, 8
    s_add_u32 s16, s16, s17
    s_sub_u32 s29, s21, s29
    s_waitcnt vmcnt(24)
    s_memrealtime s[58:59]
    v_mfma_f32_16x16x32_bf16 v[40:43], v[152:155], v[72:75], 0
    v_mfma_f32_16x16x32_bf16 v[44:47], v[160:163], v[72:75], 0
    v_mfma_f32_16x16x32_bf16 v[40:43], v[156:159], v[76:79], v[40:43]
    v_mfma_f32_16x16x32_bf16 v[44:47], v[164:167], v[76:79], v[44:47]
    v_mfma_f32_16x16x32_bf16 v[40:43], v[168:171], v[80:83], v[40:43]
    v_mfma_f32_16x16x32_bf16 v[44:47], v[176:179], v[80:83], v[44:47]
    v_mfma_f32_16x16x32_bf16 v[40:43], v[172:175], v[84:87], v[40:43]
    v_mfma_f32_16x16x32_bf16 v[44:47], v[180:183], v[84:87], v[44:47]
    s_add_u32 s42, s42, 1
    s_waitcnt lgkmcnt(0)
    s_sub_u32 s22, s58, s22
    s_ashr_i32 s22, s22, 2
    s_add_u32 s23, s23, s22
    s_add_u32 s22, s23, s29
    s_cmp_gt_i32 s22, s18
    s_cselect_b64 s[34:35], s[40:41], 0
    s_cselect_b32 s26, -14, 0
    s_cmp_lt_i32 s22, s19
    s_cselect_b64 s[34:35], s[60:61], s[34:35]
    s_cselect_b32 s26, 25, s26
    v_cndmask_b32 v26, v1, v2, s[34:35]
    v_cndmask_b32 v27, v2, v1, s[34:35]
    s_add_u32 s21, s21, s26
    buffer_load_dwordx4 v[152:155], v26, s[4:7], s53 offen offset:0 nt
    buffer_load_dwordx4 v[156:159], v27, s[4:7], s53 offen offset:0 nt
    buffer_load_dwordx4 v[160:163], v26, s[4:7], s53 offen offset:512 nt
    buffer_load_dwordx4 v[164:167], v27, s[4:7], s53 offen offset:512 nt
    buffer_load_dwordx4 v[168:171], v26, s[4:7], s53 offen offset:1024 nt
    buffer_load_dwordx4 v[172:175], v27, s[4:7], s53 offen offset:1024 nt
    buffer_load_dwordx4 v[176:179], v26, s[4:7], s53 offen offset:1536 nt
    buffer_load_dwordx4 v[180:183], v27, s[4:7], s53 offen offset:1536 nt
    v_mov_b32_dpp v9, v40 quad_perm:[0,0,0,0] row_mask:0xf bank_mask:0xf
    v_mov_b32_dpp v10, v44 quad_perm:[0,0,0,0] row_mask:0xf bank_mask:0xf
    v_add_f32_dpp v9, v41, v9 quad_perm:[1,1,1,1] row_mask:0xf bank_mask:0xf
    v_add_f32_dpp v10, v45, v10 quad_perm:[1,1,1,1] row_mask:0xf bank_mask:0xf
    v_add_f32_dpp v9, v42, v9 quad_perm:[2,2,2,2] row_mask:0xf bank_mask:0xf
    v_add_f32_dpp v10, v46, v10 quad_perm:[2,2,2,2] row_mask:0xf bank_mask:0xf
    v_add_f32_dpp v9, v43, v9 quad_perm:[3,3,3,3] row_mask:0xf bank_mask:0xf
    v_add_f32_dpp v10, v47, v10 quad_perm:[3,3,3,3] row_mask:0xf bank_mask:0xf
    v_cvt_pk_bf16_f32 v30, v9, v10
    v_max3_f32 v7, v9, v10, v7
    ds_write_b32 v22, v30 offset:896
    v_mov_b32 v28, s28
    v_mov_b32 v29, s23
    ds_write_b64 v15, v[28:29]
    s_add_u32 s28, s28, 1
    v_mfma_f32_16x16x32_bf16 v[40:43], a[128:131], v[72:75], 0
    v_mfma_f32_16x16x32_bf16 v[44:47], a[136:139], v[72:75], 0
    v_mfma_f32_16x16x32_bf16 v[40:43], a[132:135], v[76:79], v[40:43]
    v_mfma_f32_16x16x32_bf16 v[44:47], a[140:143], v[76:79], v[44:47]
    v_mfma_f32_16x16x32_bf16 v[40:43], a[144:147], v[80:83], v[40:43]
    v_mfma_f32_16x16x32_bf16 v[44:47], a[152:155], v[80:83], v[44:47]
    v_mfma_f32_16x16x32_bf16 v[40:43], a[148:151], v[84:87], v[40:43]
    v_mfma_f32_16x16x32_bf16 v[44:47], a[156:159], v[84:87], v[44:47]
    s_nop 7
    v_mov_b32_dpp v9, v40 quad_perm:[0,0,0,0] row_mask:0xf bank_mask:0xf
    v_mov_b32_dpp v10, v44 quad_perm:[0,0,0,0] row_mask:0xf bank_mask:0xf
    v_add_f32_dpp v9, v41, v9 quad_perm:[1,1,1,1] row_mask:0xf bank_mask:0xf
    v_add_f32_dpp v10, v45, v10 quad_perm:[1,1,1,1] row_mask:0xf bank_mask:0xf
    v_add_f32_dpp v9, v42, v9 quad_perm:[2,2,2,2] row_mask:0xf bank_mask:0xf
    v_add_f32_dpp v10, v46, v10 quad_perm:[2,2,2,2] row_mask:0xf bank_mask:0xf
    v_add_f32_dpp v9, v43, v9 quad_perm:[3,3,3,3] row_mask:0xf bank_mask:0xf
    v_add_f32_dpp v10, v47, v10 quad_perm:[3,3,3,3] row_mask:0xf bank_mask:0xf
    v_cvt_pk_bf16_f32 v30, v9, v10
    v_max3_f32 v7, v9, v10, v7
    ds_write_b32 v22, v30 offset:256
    v_readlane_b32 s53, v21, s42
    s_lshr_b32 s22, s20, 8
    s_add_u32 s22, s22, s88
    s_add_u32 s20, s20, 13696
    s_sub_u32 s21, s21, s27
    s_add_u32 s23, s23, s27
    s_add_u32 s22, s22, s23
    s_ashr_i32 s29, s16, 8
    s_add_u32 s16, s16, s17
    s_sub_u32 s29, s21, s29
    s_waitcnt vmcnt(24)
    s_memrealtime s[58:59]
    v_mfma_f32_16x16x32_bf16 v[40:43], v[184:187], v[72:75], 0
    v_mfma_f32_16x16x32_bf16 v[44:47], v[192:195], v[72:75], 0
    v_mfma_f32_16x16x32_bf16 v[40:43], v[188:191], v[76:79], v[40:43]
    v_mfma_f32_16x16x32_bf16 v[44:47], v[196:199], v[76:79], v[44:47]
    v_mfma_f32_16x16x32_bf16 v[40:43], v[200:203], v[80:83], v[40:43]
    v_mfma_f32_16x16x32_bf16 v[44:47], v[208:211], v[80:83], v[44:47]
    v_mfma_f32_16x16x32_bf16 v[40:43], v[204:207], v[84:87], v[40:43]
    v_mfma_f32_16x16x32_bf16 v[44:47], v[212:215], v[84:87], v[44:47]
    s_add_u32 s42, s42, 1
    s_waitcnt lgkmcnt(0)
    s_sub_u32 s22, s58, s22
    s_ashr_i32 s22, s22, 2
    s_add_u32 s23, s23, s22
    s_add_u32 s22, s23, s29
    s_cmp_gt_i32 s22, s18
    s_cselect_b64 s[36:37], s[40:41], 0
    s_cselect_b32 s27, -14, 0
    s_cmp_lt_i32 s22, s19
    s_cselect_b64 s[36:37], s[60:61], s[36:37]
    s_cselect_b32 s27, 25, s27
    v_cndmask_b32 v26, v1, v2, s[36:37]
    v_cndmask_b32 v27, v2, v1, s[36:37]
    s_add_u32 s21, s21, s27
    buffer_load_dwordx4 v[184:187], v26, s[4:7], s53 offen offset:0 nt
    buffer_load_dwordx4 v[188:191], v27, s[4:7], s53 offen offset:0 nt
    buffer_load_dwordx4 v[192:195], v26, s[4:7], s53 offen offset:512 nt
    buffer_load_dwordx4 v[196:199], v27, s[4:7], s53 offen offset:512 nt
    buffer_load_dwordx4 v[200:203], v26, s[4:7], s53 offen offset:1024 nt
    buffer_load_dwordx4 v[204:207], v27, s[4:7], s53 offen offset:1024 nt
    buffer_load_dwordx4 v[208:211], v26, s[4:7], s53 offen offset:1536 nt
    buffer_load_dwordx4 v[212:215], v27, s[4:7], s53 offen offset:1536 nt
    v_mov_b32_dpp v9, v40 quad_perm:[0,0,0,0] row_mask:0xf bank_mask:0xf
    v_mov_b32_dpp v10, v44 quad_perm:[0,0,0,0] row_mask:0xf bank_mask:0xf
    v_add_f32_dpp v9, v41, v9 quad_perm:[1,1,1,1] row_mask:0xf bank_mask:0xf
    v_add_f32_dpp v10, v45, v10 quad_perm:[1,1,1,1] row_mask:0xf bank_mask:0xf
    v_add_f32_dpp v9, v42, v9 quad_perm:[2,2,2,2] row_mask:0xf bank_mask:0xf
    v_add_f32_dpp v10, v46, v10 quad_perm:[2,2,2,2] row_mask:0xf bank_mask:0xf
    v_add_f32_dpp v9, v43, v9 quad_perm:[3,3,3,3] row_mask:0xf bank_mask:0xf
    v_add_f32_dpp v10, v47, v10 quad_perm:[3,3,3,3] row_mask:0xf bank_mask:0xf
    v_cvt_pk_bf16_f32 v30, v9, v10
    v_max3_f32 v7, v9, v10, v7
    ds_write_b32 v22, v30 offset:960
    v_mov_b32 v28, s28
    v_mov_b32 v29, s23
    ds_write_b64 v15, v[28:29]
    s_add_u32 s28, s28, 1
    v_mfma_f32_16x16x32_bf16 v[40:43], a[160:163], v[72:75], 0
    v_mfma_f32_16x16x32_bf16 v[44:47], a[168:171], v[72:75], 0
    v_mfma_f32_16x16x32_bf16 v[40:43], a[164:167], v[76:79], v[40:43]
    v_mfma_f32_16x16x32_bf16 v[44:47], a[172:175], v[76:79], v[44:47]
    v_mfma_f32_16x16x32_bf16 v[40:43], a[176:179], v[80:83], v[40:43]
    v_mfma_f32_16x16x32_bf16 v[44:47], a[184:187], v[80:83], v[44:47]
    v_mfma_f32_16x16x32_bf16 v[40:43], a[180:183], v[84:87], v[40:43]
    v_mfma_f32_16x16x32_bf16 v[44:47], a[188:191], v[84:87], v[44:47]
    s_nop 7
    v_mov_b32_dpp v9, v40 quad_perm:[0,0,0,0] row_mask:0xf bank_mask:0xf
    v_mov_b32_dpp v10, v44 quad_perm:[0,0,0,0] row_mask:0xf bank_mask:0xf
    v_add_f32_dpp v9, v41, v9 quad_perm:[1,1,1,1] row_mask:0xf bank_mask:0xf
    v_add_f32_dpp v10, v45, v10 quad_perm:[1,1,1,1] row_mask:0xf bank_mask:0xf
    v_add_f32_dpp v9, v42, v9 quad_perm:[2,2,2,2] row_mask:0xf bank_mask:0xf
    v_add_f32_dpp v10, v46, v10 quad_perm:[2,2,2,2] row_mask:0xf bank_mask:0xf
    v_add_f32_dpp v9, v43, v9 quad_perm:[3,3,3,3] row_mask:0xf bank_mask:0xf
    v_add_f32_dpp v10, v47, v10 quad_perm:[3,3,3,3] row_mask:0xf bank_mask:0xf
    v_cvt_pk_bf16_f32 v30, v9, v10
    v_max3_f32 v7, v9, v10, v7
    ds_write_b32 v22, v30 offset:320
    v_readlane_b32 s53, v21, s42
    s_lshr_b32 s22, s20, 8
    s_add_u32 s22, s22, s88
    s_add_u32 s20, s20, 13696
    s_sub_u32 s21, s21, s24
    s_add_u32 s23, s23, s24
    s_add_u32 s22, s22, s23
    s_ashr_i32 s29, s16, 8
    s_add_u32 s16, s16, s17
    s_sub_u32 s29, s21, s29
    s_waitcnt vmcnt(24)
    s_memrealtime s[58:59]
    v_mfma_f32_16x16x32_bf16 v[40:43], v[88:91], v[72:75], 0
    v_mfma_f32_16x16x32_bf16 v[44:47], v[96:99], v[72:75], 0
    v_mfma_f32_16x16x32_bf16 v[40:43], v[92:95], v[76:79], v[40:43]
    v_mfma_f32_16x16x32_bf16 v[44:47], v[100:103], v[76:79], v[44:47]
    v_mfma_f32_16x16x32_bf16 v[40:43], v[104:107], v[80:83], v[40:43]
    v_mfma_f32_16x16x32_bf16 v[44:47], v[112:115], v[80:83], v[44:47]
    v_mfma_f32_16x16x32_bf16 v[40:43], v[108:111], v[84:87], v[40:43]
    v_mfma_f32_16x16x32_bf16 v[44:47], v[116:119], v[84:87], v[44:47]
    s_add_u32 s42, s42, 1
    s_waitcnt lgkmcnt(0)
    s_sub_u32 s22, s58, s22
    s_ashr_i32 s22, s22, 2
    s_add_u32 s23, s23, s22
    s_add_u32 s22, s23, s29
    s_cmp_gt_i32 s22, s18
    s_cselect_b64 s[30:31], s[40:41], 0
    s_cselect_b32 s24, -14, 0
    s_cmp_lt_i32 s22, s19
    s_cselect_b64 s[30:31], s[60:61], s[30:31]
    s_cselect_b32 s24, 25, s24
    v_cndmask_b32 v26, v1, v2, s[30:31]
    v_cndmask_b32 v27, v2, v1, s[30:31]
    s_add_u32 s21, s21, s24
    buffer_load_dwordx4 v[88:91], v26, s[4:7], s53 offen offset:0 nt
    buffer_load_dwordx4 v[92:95], v27, s[4:7], s53 offen offset:0 nt
    buffer_load_dwordx4 v[96:99], v26, s[4:7], s53 offen offset:512 nt
    buffer_load_dwordx4 v[100:103], v27, s[4:7], s53 offen offset:512 nt
    buffer_load_dwordx4 v[104:107], v26, s[4:7], s53 offen offset:1024 nt
    buffer_load_dwordx4 v[108:111], v27, s[4:7], s53 offen offset:1024 nt
    buffer_load_dwordx4 v[112:115], v26, s[4:7], s53 offen offset:1536 nt
    buffer_load_dwordx4 v[116:119], v27, s[4:7], s53 offen offset:1536 nt
    v_mov_b32_dpp v9, v40 quad_perm:[0,0,0,0] row_mask:0xf bank_mask:0xf
    v_mov_b32_dpp v10, v44 quad_perm:[0,0,0,0] row_mask:0xf bank_mask:0xf
    v_add_f32_dpp v9, v41, v9 quad_perm:[1,1,1,1] row_mask:0xf bank_mask:0xf
    v_add_f32_dpp v10, v45, v10 quad_perm:[1,1,1,1] row_mask:0xf bank_mask:0xf
    v_add_f32_dpp v9, v42, v9 quad_perm:[2,2,2,2] row_mask:0xf bank_mask:0xf
    v_add_f32_dpp v10, v46, v10 quad_perm:[2,2,2,2] row_mask:0xf bank_mask:0xf
    v_add_f32_dpp v9, v43, v9 quad_perm:[3,3,3,3] row_mask:0xf bank_mask:0xf
    v_add_f32_dpp v10, v47, v10 quad_perm:[3,3,3,3] row_mask:0xf bank_mask:0xf
    v_cvt_pk_bf16_f32 v30, v9, v10
    v_max3_f32 v7, v9, v10, v7
    ds_write_b32 v22, v30 offset:1024
    v_mov_b32 v28, s28
    v_mov_b32 v29, s23
    ds_write_b64 v15, v[28:29]
    s_add_u32 s28, s28, 1
    v_mfma_f32_16x16x32_bf16 v[40:43], a[192:195], v[72:75], 0
    v_mfma_f32_16x16x32_bf16 v[44:47], a[200:203], v[72:75], 0
    v_mfma_f32_16x16x32_bf16 v[40:43], a[196:199], v[76:79], v[40:43]
    v_mfma_f32_16x16x32_bf16 v[44:47], a[204:207], v[76:79], v[44:47]
    v_mfma_f32_16x16x32_bf16 v[40:43], a[208:211], v[80:83], v[40:43]
    v_mfma_f32_16x16x32_bf16 v[44:47], a[216:219], v[80:83], v[44:47]
    v_mfma_f32_16x16x32_bf16 v[40:43], a[212:215], v[84:87], v[40:43]
    v_mfma_f32_16x16x32_bf16 v[44:47], a[220:223], v[84:87], v[44:47]
    s_nop 7
    v_mov_b32_dpp v9, v40 quad_perm:[0,0,0,0] row_mask:0xf bank_mask:0xf
    v_mov_b32_dpp v10, v44 quad_perm:[0,0,0,0] row_mask:0xf bank_mask:0xf
    v_add_f32_dpp v9, v41, v9 quad_perm:[1,1,1,1] row_mask:0xf bank_mask:0xf
    v_add_f32_dpp v10, v45, v10 quad_perm:[1,1,1,1] row_mask:0xf bank_mask:0xf
    v_add_f32_dpp v9, v42, v9 quad_perm:[2,2,2,2] row_mask:0xf bank_mask:0xf
    v_add_f32_dpp v10, v46, v10 quad_perm:[2,2,2,2] row_mask:0xf bank_mask:0xf
    v_add_f32_dpp v9, v43, v9 quad_perm:[3,3,3,3] row_mask:0xf bank_mask:0xf
    v_add_f32_dpp v10, v47, v10 quad_perm:[3,3,3,3] row_mask:0xf bank_mask:0xf
    v_cvt_pk_bf16_f32 v30, v9, v10
    v_max3_f32 v7, v9, v10, v7
    ds_write_b32 v22, v30 offset:384
    v_readlane_b32 s53, v21, s42
    s_lshr_b32 s22, s20, 8
    s_add_u32 s22, s22, s88
    s_add_u32 s20, s20, 13696
    s_sub_u32 s21, s21, s25
    s_add_u32 s23, s23, s25
    s_add_u32 s22, s22, s23
    s_ashr_i32 s29, s16, 8
    s_add_u32 s16, s16, s17
    s_sub_u32 s29, s21, s29
    s_waitcnt vmcnt(24)
    s_memrealtime s[58:59]
    v_mfma_f32_16x16x32_bf16 v[40:43], v[120:123], v[72:75], 0
    v_mfma_f32_16x16x32_bf16 v[44:47], v[128:131], v[72:75], 0
    v_mfma_f32_16x16x32_bf16 v[40:43], v[124:127], v[76:79], v[40:43]
    v_mfma_f32_16x16x32_bf16 v[44:47], v[132:135], v[76:79], v[44:47]
    v_mfma_f32_16x16x32_bf16 v[40:43], v[136:139], v[80:83], v[40:43]
    v_mfma_f32_16x16x32_bf16 v[44:47], v[144:147], v[80:83], v[44:47]
    v_mfma_f32_16x16x32_bf16 v[40:43], v[140:143], v[84:87], v[40:43]
    v_mfma_f32_16x16x32_bf16 v[44:47], v[148:151], v[84:87], v[44:47]
    s_add_u32 s42, s42, 1
    s_waitcnt lgkmcnt(0)
    s_sub_u32 s22, s58, s22
    s_ashr_i32 s22, s22, 2
    s_add_u32 s23, s23, s22
    s_add_u32 s22, s23, s29
    s_cmp_gt_i32 s22, s18
    s_cselect_b64 s[32:33], s[40:41], 0
    s_cselect_b32 s25, -14, 0
    s_cmp_lt_i32 s22, s19
    s_cselect_b64 s[32:33], s[60:61], s[32:33]
    s_cselect_b32 s25, 25, s25
    v_cndmask_b32 v26, v1, v2, s[32:33]
    v_cndmask_b32 v27, v2, v1, s[32:33]
    s_add_u32 s21, s21, s25
    buffer_load_dwordx4 v[120:123], v26, s[4:7], s53 offen offset:0 nt
    buffer_load_dwordx4 v[124:127], v27, s[4:7], s53 offen offset:0 nt
    buffer_load_dwordx4 v[128:131], v26, s[4:7], s53 offen offset:512 nt
    buffer_load_dwordx4 v[132:135], v27, s[4:7], s53 offen offset:512 nt
    buffer_load_dwordx4 v[136:139], v26, s[4:7], s53 offen offset:1024 nt
    buffer_load_dwordx4 v[140:143], v27, s[4:7], s53 offen offset:1024 nt
    buffer_load_dwordx4 v[144:147], v26, s[4:7], s53 offen offset:1536 nt
    buffer_load_dwordx4 v[148:151], v27, s[4:7], s53 offen offset:1536 nt
    v_mov_b32_dpp v9, v40 quad_perm:[0,0,0,0] row_mask:0xf bank_mask:0xf
    v_mov_b32_dpp v10, v44 quad_perm:[0,0,0,0] row_mask:0xf bank_mask:0xf
    v_add_f32_dpp v9, v41, v9 quad_perm:[1,1,1,1] row_mask:0xf bank_mask:0xf
    v_add_f32_dpp v10, v45, v10 quad_perm:[1,1,1,1] row_mask:0xf bank_mask:0xf
    v_add_f32_dpp v9, v42, v9 quad_perm:[2,2,2,2] row_mask:0xf bank_mask:0xf
    v_add_f32_dpp v10, v46, v10 quad_perm:[2,2,2,2] row_mask:0xf bank_mask:0xf
    v_add_f32_dpp v9, v43, v9 quad_perm:[3,3,3,3] row_mask:0xf bank_mask:0xf
    v_add_f32_dpp v10, v47, v10 quad_perm:[3,3,3,3] row_mask:0xf bank_mask:0xf
    v_cvt_pk_bf16_f32 v30, v9, v10
    v_max3_f32 v7, v9, v10, v7
    ds_write_b32 v22, v30 offset:1088
    v_mov_b32 v28, s28
    v_mov_b32 v29, s23
    ds_write_b64 v15, v[28:29]
    s_add_u32 s28, s28, 1
    v_mfma_f32_16x16x32_bf16 v[40:43], a[224:227], v[72:75], 0
    v_mfma_f32_16x16x32_bf16 v[44:47], a[232:235], v[72:75], 0
    v_mfma_f32_16x16x32_bf16 v[40:43], a[228:231], v[76:79], v[40:43]
    v_mfma_f32_16x16x32_bf16 v[44:47], a[236:239], v[76:79], v[44:47]
    v_mfma_f32_16x16x32_bf16 v[40:43], a[240:243], v[80:83], v[40:43]
    v_mfma_f32_16x16x32_bf16 v[44:47], a[248:251], v[80:83], v[44:47]
    v_mfma_f32_16x16x32_bf16 v[40:43], a[244:247], v[84:87], v[40:43]
    v_mfma_f32_16x16x32_bf16 v[44:47], a[252:255], v[84:87], v[44:47]
    s_nop 7
    v_mov_b32_dpp v9, v40 quad_perm:[0,0,0,0] row_mask:0xf bank_mask:0xf
    v_mov_b32_dpp v10, v44 quad_perm:[0,0,0,0] row_mask:0xf bank_mask:0xf
    v_add_f32_dpp v9, v41, v9 quad_perm:[1,1,1,1] row_mask:0xf bank_mask:0xf
    v_add_f32_dpp v10, v45, v10 quad_perm:[1,1,1,1] row_mask:0xf bank_mask:0xf
    v_add_f32_dpp v9, v42, v9 quad_perm:[2,2,2,2] row_mask:0xf bank_mask:0xf
    v_add_f32_dpp v10, v46, v10 quad_perm:[2,2,2,2] row_mask:0xf bank_mask:0xf
    v_add_f32_dpp v9, v43, v9 quad_perm:[3,3,3,3] row_mask:0xf bank_mask:0xf
    v_add_f32_dpp v10, v47, v10 quad_perm:[3,3,3,3] row_mask:0xf bank_mask:0xf
    v_cvt_pk_bf16_f32 v30, v9, v10
    v_max3_f32 v7, v9, v10, v7
    ds_write_b32 v22, v30 offset:448
    v_readlane_b32 s53, v21, s42
    s_lshr_b32 s22, s20, 8
    s_add_u32 s22, s22, s88
    s_add_u32 s20, s20, 13696
    s_sub_u32 s21, s21, s26
    s_add_u32 s23, s23, s26
    s_add_u32 s22, s22, s23
    s_ashr_i32 s29, s16, 8
    s_add_u32 s16, s16, s17
    s_sub_u32 s29, s21, s29
    s_waitcnt vmcnt(24)
    s_memrealtime s[58:59]
    v_mfma_f32_16x16x32_bf16 v[40:43], v[152:155], v[72:75], 0
    v_mfma_f32_16x16x32_bf16 v[44:47], v[160:163], v[72:75], 0
    v_mfma_f32_16x16x32_bf16 v[40:43], v[156:159], v[76:79], v[40:43]
    v_mfma_f32_16x16x32_bf16 v[44:47], v[164:167], v[76:79], v[44:47]
    v_mfma_f32_16x16x32_bf16 v[40:43], v[168:171], v[80:83], v[40:43]
    v_mfma_f32_16x16x32_bf16 v[44:47], v[176:179], v[80:83], v[44:47]
    v_mfma_f32_16x16x32_bf16 v[40:43], v[172:175], v[84:87], v[40:43]
    v_mfma_f32_16x16x32_bf16 v[44:47], v[180:183], v[84:87], v[44:47]
    s_add_u32 s42, s42, 1
    s_waitcnt lgkmcnt(0)
    s_sub_u32 s22, s58, s22
    s_ashr_i32 s22, s22, 2
    s_add_u32 s23, s23, s22
    s_add_u32 s22, s23, s29
    s_cmp_gt_i32 s22, s18
    s_cselect_b64 s[34:35], s[40:41], 0
    s_cselect_b32 s26, -14, 0
    s_cmp_lt_i32 s22, s19
    s_cselect_b64 s[34:35], s[60:61], s[34:35]
    s_cselect_b32 s26, 25, s26
    v_cndmask_b32 v26, v1, v2, s[34:35]
    v_cndmask_b32 v27, v2, v1, s[34:35]
    s_add_u32 s21, s21, s26
    buffer_load_dwordx4 v[152:155], v26, s[4:7], s53 offen offset:0 nt
    buffer_load_dwordx4 v[156:159], v27, s[4:7], s53 offen offset:0 nt
    buffer_load_dwordx4 v[160:163], v26, s[4:7], s53 offen offset:512 nt
    buffer_load_dwordx4 v[164:167], v27, s[4:7], s53 offen offset:512 nt
    buffer_load_dwordx4 v[168:171], v26, s[4:7], s53 offen offset:1024 nt
    buffer_load_dwordx4 v[172:175], v27, s[4:7], s53 offen offset:1024 nt
    buffer_load_dwordx4 v[176:179], v26, s[4:7], s53 offen offset:1536 nt
    buffer_load_dwordx4 v[180:183], v27, s[4:7], s53 offen offset:1536 nt
    v_mov_b32_dpp v9, v40 quad_perm:[0,0,0,0] row_mask:0xf bank_mask:0xf
    v_mov_b32_dpp v10, v44 quad_perm:[0,0,0,0] row_mask:0xf bank_mask:0xf
    v_add_f32_dpp v9, v41, v9 quad_perm:[1,1,1,1] row_mask:0xf bank_mask:0xf
    v_add_f32_dpp v10, v45, v10 quad_perm:[1,1,1,1] row_mask:0xf bank_mask:0xf
    v_add_f32_dpp v9, v42, v9 quad_perm:[2,2,2,2] row_mask:0xf bank_mask:0xf
    v_add_f32_dpp v10, v46, v10 quad_perm:[2,2,2,2] row_mask:0xf bank_mask:0xf
    v_add_f32_dpp v9, v43, v9 quad_perm:[3,3,3,3] row_mask:0xf bank_mask:0xf
    v_add_f32_dpp v10, v47, v10 quad_perm:[3,3,3,3] row_mask:0xf bank_mask:0xf
    v_cvt_pk_bf16_f32 v30, v9, v10
    v_max3_f32 v7, v9, v10, v7
    ds_write_b32 v22, v30 offset:1152
    v_mov_b32 v28, s28
    v_mov_b32 v29, s23
    ds_write_b64 v15, v[28:29]
    s_add_u32 s28, s28, 1
    v_readlane_b32 s53, v21, s42
    s_lshr_b32 s22, s20, 8
    s_add_u32 s22, s22, s88
    s_add_u32 s20, s20, 13696
    s_sub_u32 s21, s21, s27
    s_add_u32 s23, s23, s27
    s_add_u32 s22, s22, s23
    s_ashr_i32 s29, s16, 8
    s_add_u32 s16, s16, s17
    s_sub_u32 s29, s21, s29
    s_waitcnt vmcnt(24)
    s_memrealtime s[58:59]
    v_mfma_f32_16x16x32_bf16 v[40:43], v[184:187], v[72:75], 0
    v_mfma_f32_16x16x32_bf16 v[44:47], v[192:195], v[72:75], 0
    v_mfma_f32_16x16x32_bf16 v[40:43], v[188:191], v[76:79], v[40:43]
    v_mfma_f32_16x16x32_bf16 v[44:47], v[196:199], v[76:79], v[44:47]
    v_mfma_f32_16x16x32_bf16 v[40:43], v[200:203], v[80:83], v[40:43]
    v_mfma_f32_16x16x32_bf16 v[44:47], v[208:211], v[80:83], v[44:47]
    v_mfma_f32_16x16x32_bf16 v[40:43], v[204:207], v[84:87], v[40:43]
    v_mfma_f32_16x16x32_bf16 v[44:47], v[212:215], v[84:87], v[44:47]
    s_add_u32 s42, s42, 1
    s_waitcnt lgkmcnt(0)
    s_sub_u32 s22, s58, s22
    s_ashr_i32 s22, s22, 2
    s_add_u32 s23, s23, s22
    s_add_u32 s22, s23, s29
    s_cmp_gt_i32 s22, s18
    s_cselect_b64 s[36:37], s[40:41], 0
    s_cselect_b32 s27, -14, 0
    s_cmp_lt_i32 s22, s19
    s_cselect_b64 s[36:37], s[60:61], s[36:37]
    s_cselect_b32 s27, 25, s27
    v_cndmask_b32 v26, v1, v2, s[36:37]
    v_cndmask_b32 v27, v2, v1, s[36:37]
    s_add_u32 s21, s21, s27
    buffer_load_dwordx4 v[184:187], v26, s[4:7], s53 offen offset:0 nt
    buffer_load_dwordx4 v[188:191], v27, s[4:7], s53 offen offset:0 nt
    buffer_load_dwordx4 v[192:195], v26, s[4:7], s53 offen offset:512 nt
    buffer_load_dwordx4 v[196:199], v27, s[4:7], s53 offen offset:512 nt
    buffer_load_dwordx4 v[200:203], v26, s[4:7], s53 offen offset:1024 nt
    buffer_load_dwordx4 v[204:207], v27, s[4:7], s53 offen offset:1024 nt
    buffer_load_dwordx4 v[208:211], v26, s[4:7], s53 offen offset:1536 nt
    buffer_load_dwordx4 v[212:215], v27, s[4:7], s53 offen offset:1536 nt
    v_mov_b32_dpp v9, v40 quad_perm:[0,0,0,0] row_mask:0xf bank_mask:0xf
    v_mov_b32_dpp v10, v44 quad_perm:[0,0,0,0] row_mask:0xf bank_mask:0xf
    v_add_f32_dpp v9, v41, v9 quad_perm:[1,1,1,1] row_mask:0xf bank_mask:0xf
    v_add_f32_dpp v10, v45, v10 quad_perm:[1,1,1,1] row_mask:0xf bank_mask:0xf
    v_add_f32_dpp v9, v42, v9 quad_perm:[2,2,2,2] row_mask:0xf bank_mask:0xf
    v_add_f32_dpp v10, v46, v10 quad_perm:[2,2,2,2] row_mask:0xf bank_mask:0xf
    v_add_f32_dpp v9, v43, v9 quad_perm:[3,3,3,3] row_mask:0xf bank_mask:0xf
    v_add_f32_dpp v10, v47, v10 quad_perm:[3,3,3,3] row_mask:0xf bank_mask:0xf
    v_cvt_pk_bf16_f32 v30, v9, v10
    v_max3_f32 v7, v9, v10, v7
    ds_write_b32 v22, v30 offset:1216
    v_mov_b32 v28, s28
    v_mov_b32 v29, s23
    ds_write_b64 v15, v[28:29]
    s_add_u32 s28, s28, 1
    ds_read_b128 v[32:35], v20 offset:1088
st_loopK_1:
    s_waitcnt lgkmcnt(0)
    v_readfirstlane_b32 s16, v32
    v_readfirstlane_b32 s17, v33
    v_readfirstlane_b32 s18, v34
    v_readfirstlane_b32 s19, v35
    s_mul_i32 s29, s17, s28
    s_add_u32 s16, s16, s29
    v_readlane_b32 s53, v21, s42
    s_xor_b64 exec, s[38:39], s[30:31]
    v_swap_b32 v72, v76
    v_swap_b32 v73, v77
    v_swap_b32 v74, v78
    v_swap_b32 v75, v79
    v_swap_b32 v80, v84
    v_swap_b32 v81, v85
    v_swap_b32 v82, v86
    v_swap_b32 v83, v87
    s_mov_b64 s[38:39], s[30:31]
    s_mov_b64 exec, -1
    s_lshr_b32 s22, s20, 8
    s_add_u32 s22, s22, s88
    s_add_u32 s20, s20, 13696
    s_sub_u32 s21, s21, s24
    s_add_u32 s23, s23, s24
    s_add_u32 s22, s22, s23
    s_ashr_i32 s29, s16, 8
    s_add_u32 s16, s16, s17
    s_sub_u32 s29, s21, s29
    s_waitcnt vmcnt(24)
    s_memrealtime s[58:59]
    v_mfma_f32_16x16x32_bf16 v[40:43], v[88:91], v[72:75], 0
    v_mfma_f32_16x16x32_bf16 v[44:47], v[96:99], v[72:75], 0
    v_mfma_f32_16x16x32_bf16 v[40:43], v[92:95], v[76:79], v[40:43]
    v_mfma_f32_16x16x32_bf16 v[44:47], v[100:103], v[76:79], v[44:47]
    v_mfma_f32_16x16x32_bf16 v[40:43], v[104:107], v[80:83], v[40:43]
    v_mfma_f32_16x16x32_bf16 v[44:47], v[112:115], v[80:83], v[44:47]
    v_mfma_f32_16x16x32_bf16 v[40:43], v[108:111], v[84:87], v[40:43]
    v_mfma_f32_16x16x32_bf16 v[44:47], v[116:119], v[84:87], v[44:47]
    s_add_u32 s42, s42, 1
    s_waitcnt lgkmcnt(0)
    s_sub_u32 s22, s58, s22
    s_ashr_i32 s22, s22, 2
    s_add_u32 s23, s23, s22
    s_add_u32 s22, s23, s29
    s_cmp_gt_i32 s22, s18
    s_cselect_b64 s[30:31], s[40:41], 0
    s_cselect_b32 s24, -14, 0
    s_cmp_lt_i32 s22, s19
    s_cselect_b64 s[30:31], s[60:61], s[30:31]
    s_cselect_b32 s24, 25, s24
    v_cndmask_b32 v26, v1, v2, s[30:31]
    v_cndmask_b32 v27, v2, v1, s[30:31]
    s_add_u32 s21, s21, s24
    buffer_load_dwordx4 v[88:91], v26, s[4:7], s53 offen offset:0 nt
    buffer_load_dwordx4 v[92:95], v27, s[4:7], s53 offen offset:0 nt
    buffer_load_dwordx4 v[96:99], v26, s[4:7], s53 offen offset:512 nt
    buffer_load_dwordx4 v[100:103], v27, s[4:7], s53 offen offset:512 nt
    buffer_load_dwordx4 v[104:107], v26, s[4:7], s53 offen offset:1024 nt
    buffer_load_dwordx4 v[108:111], v27, s[4:7], s53 offen offset:1024 nt
    buffer_load_dwordx4 v[112:115], v26, s[4:7], s53 offen offset:1536 nt
    buffer_load_dwordx4 v[116:119], v27, s[4:7], s53 offen offset:1536 nt
    v_mov_b32_dpp v9, v40 quad_perm:[0,0,0,0] row_mask:0xf bank_mask:0xf
    v_mov_b32_dpp v10, v44 quad_perm:[0,0,0,0] row_mask:0xf bank_mask:0xf
    v_add_f32_dpp v9, v41, v9 quad_perm:[1,1,1,1] row_mask:0xf bank_mask:0xf
    v_add_f32_dpp v10, v45, v10 quad_perm:[1,1,1,1] row_mask:0xf bank_mask:0xf
    v_add_f32_dpp v9, v42, v9 quad_perm:[2,2,2,2] row_mask:0xf bank_mask:0xf
    v_add_f32_dpp v10, v46, v10 quad_perm:[2,2,2,2] row_mask:0xf bank_mask:0xf
    v_add_f32_dpp v9, v43, v9 quad_perm:[3,3,3,3] row_mask:0xf bank_mask:0xf
    v_add_f32_dpp v10, v47, v10 quad_perm:[3,3,3,3] row_mask:0xf bank_mask:0xf
    v_cvt_pk_bf16_f32 v30, v9, v10
    v_max3_f32 v7, v9, v10, v7
    ds_write_b32 v23, v30 offset:0
    v_mov_b32 v28, s28
    v_mov_b32 v29, s23
    ds_write_b64 v15, v[28:29]
    s_add_u32 s28, s28, 1
    v_readlane_b32 s53, v21, s42
    s_xor_b64 exec, s[38:39], s[32:33]
    v_swap_b32 v72, v76
    v_swap_b32 v73, v77
    v_swap_b32 v74, v78
    v_swap_b32 v75, v79
    v_swap_b32 v80, v84
    v_swap_b32 v81, v85
    v_swap_b32 v82, v86
    v_swap_b32 v83, v87
    s_mov_b64 s[38:39], s[32:33]
    s_mov_b64 exec, -1
    s_lshr_b32 s22, s20, 8
    s_add_u32 s22, s22, s88
    s_add_u32 s20, s20, 13696
    s_sub_u32 s21, s21, s25
    s_add_u32 s23, s23, s25
    s_add_u32 s22, s22, s23
    s_ashr_i32 s29, s16, 8
    s_add_u32 s16, s16, s17
    s_sub_u32 s29, s21, s29
    s_waitcnt vmcnt(24)
    s_memrealtime s[58:59]
    v_mfma_f32_16x16x32_bf16 v[40:43], v[120:123], v[72:75], 0
    v_mfma_f32_16x16x32_bf16 v[44:47], v[128:131], v[72:75], 0
    v_mfma_f32_16x16x32_bf16 v[40:43], v[124:127], v[76:79], v[40:43]
    v_mfma_f32_16x16x32_bf16 v[44:47], v[132:135], v[76:79], v[44:47]
    v_mfma_f32_16x16x32_bf16 v[40:43], v[136:139], v[80:83], v[40:43]
    v_mfma_f32_16x16x32_bf16 v[44:47], v[144:147], v[80:83], v[44:47]
    v_mfma_f32_16x16x32_bf16 v[40:43], v[140:143], v[84:87], v[40:43]
    v_mfma_f32_16x16x32_bf16 v[44:47], v[148:151], v[84:87], v[44:47]
    s_add_u32 s42, s42, 1
    s_waitcnt lgkmcnt(0)
    s_sub_u32 s22, s58, s22
    s_ashr_i32 s22, s22, 2
    s_add_u32 s23, s23, s22
    s_add_u32 s22, s23, s29
    s_cmp_gt_i32 s22, s18
    s_cselect_b64 s[32:33], s[40:41], 0
    s_cselect_b32 s25, -14, 0
    s_cmp_lt_i32 s22, s19
    s_cselect_b64 s[32:33], s[60:61], s[32:33]
    s_cselect_b32 s25, 25, s25
    v_cndmask_b32 v26, v1, v2, s[32:33]
    v_cndmask_b32 v27, v2, v1, s[32:33]
    s_add_u32 s21, s21, s25
    buffer_load_dwordx4 v[120:123], v26, s[4:7], s53 offen offset:0 nt
    buffer_load_dwordx4 v[124:127], v27, s[4:7], s53 offen offset:0 nt
    buffer_load_dwordx4 v[128:131], v26, s[4:7], s53 offen offset:512 nt
    buffer_load_dwordx4 v[132:135], v27, s[4:7], s53 offen offset:512 nt
    buffer_load_dwordx4 v[136:139], v26, s[4:7], s53 offen offset:1024 nt
    buffer_load_dwordx4 v[140:143], v27, s[4:7], s53 offen offset:1024 nt
    buffer_load_dwordx4 v[144:147], v26, s[4:7], s53 offen offset:1536 nt
    buffer_load_dwordx4 v[148:151], v27, s[4:7], s53 offen offset:1536 nt
    v_mov_b32_dpp v9, v40 quad_perm:[0,0,0,0] row_mask:0xf bank_mask:0xf
    v_mov_b32_dpp v10, v44 quad_perm:[0,0,0,0] row_mask:0xf bank_mask:0xf
    v_add_f32_dpp v9, v41, v9 quad_perm:[1,1,1,1] row_mask:0xf bank_mask:0xf
    v_add_f32_dpp v10, v45, v10 quad_perm:[1,1,1,1] row_mask:0xf bank_mask:0xf
    v_add_f32_dpp v9, v42, v9 quad_perm:[2,2,2,2] row_mask:0xf bank_mask:0xf
    v_add_f32_dpp v10, v46, v10 quad_perm:[2,2,2,2] row_mask:0xf bank_mask:0xf
    v_add_f32_dpp v9, v43, v9 quad_perm:[3,3,3,3] row_mask:0xf bank_mask:0xf
    v_add_f32_dpp v10, v47, v10 quad_perm:[3,3,3,3] row_mask:0xf bank_mask:0xf
    v_cvt_pk_bf16_f32 v30, v9, v10
    v_max3_f32 v7, v9, v10, v7
    ds_write_b32 v23, v30 offset:64
    v_mov_b32 v28, s28
    v_mov_b32 v29, s23
    ds_write_b64 v15, v[28:29]
    s_add_u32 s28, s28, 1
    v_readlane_b32 s53, v21, s42
    s_xor_b64 exec, s[38:39], s[34:35]
    v_swap_b32 v72, v76
    v_swap_b32 v73, v77
    v_swap_b32 v74, v78
    v_swap_b32 v75, v79
    v_swap_b32 v80, v84
    v_swap_b32 v81, v85
    v_swap_b32 v82, v86
    v_swap_b32 v83, v87
    s_mov_b64 s[38:39], s[34:35]
    s_mov_b64 exec, -1
    s_lshr_b32 s22, s20, 8
    s_add_u32 s22, s22, s88
    s_add_u32 s20, s20, 13696
    s_sub_u32 s21, s21, s26
    s_add_u32 s23, s23, s26
    s_add_u32 s22, s22, s23
    s_ashr_i32 s29, s16, 8
    s_add_u32 s16, s16, s17
    s_sub_u32 s29, s21, s29
    s_waitcnt vmcnt(24)
    s_memrealtime s[58:59]
    v_mfma_f32_16x16x32_bf16 v[40:43], v[152:155], v[72:75], 0
    v_mfma_f32_16x16x32_bf16 v[44:47], v[160:163], v[72:75], 0
    v_mfma_f32_16x16x32_bf16 v[40:43], v[156:159], v[76:79], v[40:43]
    v_mfma_f32_16x16x32_bf16 v[44:47], v[164:167], v[76:79], v[44:47]
    v_mfma_f32_16x16x32_bf16 v[40:43], v[168:171], v[80:83], v[40:43]
    v_mfma_f32_16x16x32_bf16 v[44:47], v[176:179], v[80:83], v[44:47]
    v_mfma_f32_16x16x32_bf16 v[40:43], v[172:175], v[84:87], v[40:43]
    v_mfma_f32_16x16x32_bf16 v[44:47], v[180:183], v[84:87], v[44:47]
    s_add_u32 s42, s42, 1
    s_waitcnt lgkmcnt(0)
    s_sub_u32 s22, s58, s22
    s_ashr_i32 s22, s22, 2
    s_add_u32 s23, s23, s22
    s_add_u32 s22, s23, s29
    s_cmp_gt_i32 s22, s18
    s_cselect_b64 s[34:35], s[40:41], 0
    s_cselect_b32 s26, -14, 0
    s_cmp_lt_i32 s22, s19
    s_cselect_b64 s[34:35], s[60:61], s[34:35]
    s_cselect_b32 s26, 25, s26
    v_cndmask_b32 v26, v1, v2, s[34:35]
    v_cndmask_b32 v27, v2, v1, s[34:35]
    s_add_u32 s21, s21, s26
    buffer_load_dwordx4 v[152:155], v26, s[4:7], s53 offen offset:0 nt
    buffer_load_dwordx4 v[156:159], v27, s[4:7], s53 offen offset:0 nt
    buffer_load_dwordx4 v[160:163], v26, s[4:7], s53 offen offset:512 nt
    buffer_load_dwordx4 v[164:167], v27, s[4:7], s53 offen offset:512 nt
    buffer_load_dwordx4 v[168:171], v26, s[4:7], s53 offen offset:1024 nt
    buffer_load_dwordx4 v[172:175], v27, s[4:7], s53 offen offset:1024 nt
    buffer_load_dwordx4 v[176:179], v26, s[4:7], s53 offen offset:1536 nt
    buffer_load_dwordx4 v[180:183], v27, s[4:7], s53 offen offset:1536 nt
    v_mov_b32_dpp v9, v40 quad_perm:[0,0,0,0] row_mask:0xf bank_mask:0xf
    v_mov_b32_dpp v10, v44 quad_perm:[0,0,0,0] row_mask:0xf bank_mask:0xf
    v_add_f32_dpp v9, v41, v9 quad_perm:[1,1,1,1] row_mask:0xf bank_mask:0xf
    v_add_f32_dpp v10, v45, v10 quad_perm:[1,1,1,1] row_mask:0xf bank_mask:0xf
    v_add_f32_dpp v9, v42, v9 quad_perm:[2,2,2,2] row_mask:0xf bank_mask:0xf
    v_add_f32_dpp v10, v46, v10 quad_perm:[2,2,2,2] row_mask:0xf bank_mask:0xf
    v_add_f32_dpp v9, v43, v9 quad_perm:[3,3,3,3] row_mask:0xf bank_mask:0xf
    v_add_f32_dpp v10, v47, v10 quad_perm:[3,3,3,3] row_mask:0xf bank_mask:0xf
    v_cvt_pk_bf16_f32 v30, v9, v10
    v_max3_f32 v7, v9, v10, v7
    ds_write_b32 v23, v30 offset:128
    v_mov_b32 v28, s28
    v_mov_b32 v29, s23
    ds_write_b64 v15, v[28:29]
    s_add_u32 s28, s28, 1
    v_readlane_b32 s53, v21, s42
    s_xor_b64 exec, s[38:39], s[36:37]
    v_swap_b32 v72, v76
    v_swap_b32 v73, v77
    v_swap_b32 v74, v78
    v_swap_b32 v75, v79
    v_swap_b32 v80, v84
    v_swap_b32 v81, v85
    v_swap_b32 v82, v86
    v_swap_b32 v83, v87
    s_mov_b64 s[38:39], s[36:37]
    s_mov_b64 exec, -1
    s_lshr_b32 s22, s20, 8
    s_add_u32 s22, s22, s88
    s_add_u32 s20, s20, 13696
    s_sub_u32 s21, s21, s27
    s_add_u32 s23, s23, s27
    s_add_u32 s22, s22, s23
    s_ashr_i32 s29, s16, 8
    s_add_u32 s16, s16, s17
    s_sub_u32 s29, s21, s29
    s_waitcnt vmcnt(24)
    s_memrealtime s[58:59]
    v_mfma_f32_16x16x32_bf16 v[40:43], v[184:187], v[72:75], 0
    v_mfma_f32_16x16x32_bf16 v[44:47], v[192:195], v[72:75], 0
    v_mfma_f32_16x16x32_bf16 v[40:43], v[188:191], v[76:79], v[40:43]
    v_mfma_f32_16x16x32_bf16 v[44:47], v[196:199], v[76:79], v[44:47]
    v_mfma_f32_16x16x32_bf16 v[40:43], v[200:203], v[80:83], v[40:43]
    v_mfma_f32_16x16x32_bf16 v[44:47], v[208:211], v[80:83], v[44:47]
    v_mfma_f32_16x16x32_bf16 v[40:43], v[204:207], v[84:87], v[40:43]
    v_mfma_f32_16x16x32_bf16 v[44:47], v[212:215], v[84:87], v[44:47]
    s_add_u32 s42, s42, 1
    s_waitcnt lgkmcnt(0)
    s_sub_u32 s22, s58, s22
    s_ashr_i32 s22, s22, 2
    s_add_u32 s23, s23, s22
    s_add_u32 s22, s23, s29
    s_cmp_gt_i32 s22, s18
    s_cselect_b64 s[36:37], s[40:41], 0
    s_cselect_b32 s27, -14, 0
    s_cmp_lt_i32 s22, s19
    s_cselect_b64 s[36:37], s[60:61], s[36:37]
    s_cselect_b32 s27, 25, s27
    v_cndmask_b32 v26, v1, v2, s[36:37]
    v_cndmask_b32 v27, v2, v1, s[36:37]
    s_add_u32 s21, s21, s27
    buffer_load_dwordx4 v[184:187], v26, s[4:7], s53 offen offset:0 nt
    buffer_load_dwordx4 v[188:191], v27, s[4:7], s53 offen offset:0 nt
    buffer_load_dwordx4 v[192:195], v26, s[4:7], s53 offen offset:512 nt
    buffer_load_dwordx4 v[196:199], v27, s[4:7], s53 offen offset:512 nt
    buffer_load_dwordx4 v[200:203], v26, s[4:7], s53 offen offset:1024 nt
    buffer_load_dwordx4 v[204:207], v27, s[4:7], s53 offen offset:1024 nt
    buffer_load_dwordx4 v[208:211], v26, s[4:7], s53 offen offset:1536 nt
    buffer_load_dwordx4 v[212:215], v27, s[4:7], s53 offen offset:1536 nt
    v_mov_b32_dpp v9, v40 quad_perm:[0,0,0,0] row_mask:0xf bank_mask:0xf
    v_mov_b32_dpp v10, v44 quad_perm:[0,0,0,0] row_mask:0xf bank_mask:0xf
    v_add_f32_dpp v9, v41, v9 quad_perm:[1,1,1,1] row_mask:0xf bank_mask:0xf
    v_add_f32_dpp v10, v45, v10 quad_perm:[1,1,1,1] row_mask:0xf bank_mask:0xf
    v_add_f32_dpp v9, v42, v9 quad_perm:[2,2,2,2] row_mask:0xf bank_mask:0xf
    v_add_f32_dpp v10, v46, v10 quad_perm:[2,2,2,2] row_mask:0xf bank_mask:0xf
    v_add_f32_dpp v9, v43, v9 quad_perm:[3,3,3,3] row_mask:0xf bank_mask:0xf
    v_add_f32_dpp v10, v47, v10 quad_perm:[3,3,3,3] row_mask:0xf bank_mask:0xf
    v_cvt_pk_bf16_f32 v30, v9, v10
    v_max3_f32 v7, v9, v10, v7
    ds_write_b32 v23, v30 offset:192
    v_mov_b32 v28, s28
    v_mov_b32 v29, s23
    ds_write_b64 v15, v[28:29]
    s_add_u32 s28, s28, 1
    ds_read_b128 v[32:35], v20 offset:1088
    v_add_u32 v23, 256, v23
    s_cmp_lt_u32 s42, 64
    s_cbranch_scc1 st_loopK_1
    s_waitcnt lgkmcnt(0)
    v_readfirstlane_b32 s16, v32
    v_readfirstlane_b32 s17, v33
    v_readfirstlane_b32 s18, v34
    v_readfirstlane_b32 s19, v35
    s_mul_i32 s29, s17, s28
    s_add_u32 s16, s16, s29
    s_mov_b32 s42, 0
    s_mov_b32 s40, 0xc0c0c0c0
    s_mov_b32 s60, 0xc0c0c0c
    s_mov_b32 s41, 0xc0c0c0c0
    s_mov_b32 s61, 0xc0c0c0c
    v_readlane_b32 s53, v21, s42
    s_xor_b64 exec, s[38:39], s[30:31]
    v_swap_b32 v72, v76
    v_swap_b32 v73, v77
    v_swap_b32 v74, v78
    v_swap_b32 v75, v79
    v_swap_b32 v80, v84
    v_swap_b32 v81, v85
    v_swap_b32 v82, v86
    v_swap_b32 v83, v87
    s_mov_b64 s[38:39], s[30:31]
    s_mov_b64 exec, -1
    s_lshr_b32 s22, s20, 8
    s_add_u32 s22, s22, s88
    s_add_u32 s20, s20, 13696
    s_sub_u32 s21, s21, s24
    s_add_u32 s23, s23, s24
    s_add_u32 s22, s22, s23
    s_ashr_i32 s29, s16, 8
    s_add_u32 s16, s16, s17
    s_sub_u32 s29, s21, s29
    s_waitcnt vmcnt(24)
    s_memrealtime s[58:59]
    v_mfma_f32_16x16x32_bf16 v[40:43], v[88:91], v[72:75], 0
    v_mfma_f32_16x16x32_bf16 v[44:47], v[96:99], v[72:75], 0
    v_mfma_f32_16x16x32_bf16 v[40:43], v[92:95], v[76:79], v[40:43]
    v_mfma_f32_16x16x32_bf16 v[44:47], v[100:103], v[76:79], v[44:47]
    v_mfma_f32_16x16x32_bf16 v[40:43], v[104:107], v[80:83], v[40:43]
    v_mfma_f32_16x16x32_bf16 v[44:47], v[112:115], v[80:83], v[44:47]
    v_mfma_f32_16x16x32_bf16 v[40:43], v[108:111], v[84:87], v[40:43]
    v_mfma_f32_16x16x32_bf16 v[44:47], v[116:119], v[84:87], v[44:47]
    s_add_u32 s42, s42, 1
    s_waitcnt lgkmcnt(0)
    s_sub_u32 s22, s58, s22
    s_ashr_i32 s22, s22, 2
    s_add_u32 s23, s23, s22
    s_add_u32 s22, s23, s29
    s_cmp_gt_i32 s22, s18
    s_cselect_b64 s[30:31], s[40:41], 0
    s_cselect_b32 s24, -14, 0
    s_cmp_lt_i32 s22, s19
    s_cselect_b64 s[30:31], s[60:61], s[30:31]
    s_cselect_b32 s24, 25, s24
    v_cndmask_b32 v26, v3, v4, s[30:31]
    v_cndmask_b32 v27, v4, v3, s[30:31]
    s_add_u32 s21, s21, s24
    buffer_load_dwordx4 v[88:91], v26, s[8:11], s53 offen offset:0 nt
    buffer_load_dwordx4 v[92:95], v27, s[8:11], s53 offen offset:0 nt
    buffer_load_dwordx4 v[96:99], v26, s[8:11], s53 offen offset:512 nt
    buffer_load_dwordx4 v[100:103], v27, s[8:11], s53 offen offset:512 nt
    buffer_load_dwordx4 v[104:107], v26, s[8:11], s53 offen offset:1024 nt
    buffer_load_dwordx4 v[108:111], v27, s[8:11], s53 offen offset:1024 nt
    buffer_load_dwordx4 v[112:115], v26, s[8:11], s53 offen offset:1536 nt
    buffer_load_dwordx4 v[116:119], v27, s[8:11], s53 offen offset:1536 nt
    v_mov_b32_dpp v9, v40 quad_perm:[0,0,0,0] row_mask:0xf bank_mask:0xf
    v_mov_b32_dpp v10, v44 quad_perm:[0,0,0,0] row_mask:0xf bank_mask:0xf
    v_add_f32_dpp v9, v41, v9 quad_perm:[1,1,1,1] row_mask:0xf bank_mask:0xf
    v_add_f32_dpp v10, v45, v10 quad_perm:[1,1,1,1] row_mask:0xf bank_mask:0xf
    v_add_f32_dpp v9, v42, v9 quad_perm:[2,2,2,2] row_mask:0xf bank_mask:0xf
    v_add_f32_dpp v10, v46, v10 quad_perm:[2,2,2,2] row_mask:0xf bank_mask:0xf
    v_add_f32_dpp v9, v43, v9 quad_perm:[3,3,3,3] row_mask:0xf bank_mask:0xf
    v_add_f32_dpp v10, v47, v10 quad_perm:[3,3,3,3] row_mask:0xf bank_mask:0xf
    v_cvt_pk_bf16_f32 v30, v9, v10
    v_max3_f32 v7, v9, v10, v7
    ds_write_b32 v23, v30 offset:0
    v_mov_b32 v28, s28
    v_mov_b32 v29, s23
    ds_write_b64 v15, v[28:29]
    s_add_u32 s28, s28, 1
    v_readlane_b32 s53, v21, s42
    s_xor_b64 exec, s[38:39], s[32:33]
    v_swap_b32 v72, v76
    v_swap_b32 v73, v77
    v_swap_b32 v74, v78
    v_swap_b32 v75, v79
    v_swap_b32 v80, v84
    v_swap_b32 v81, v85
    v_swap_b32 v82, v86
    v_swap_b32 v83, v87
    s_mov_b64 s[38:39], s[32:33]
    s_mov_b64 exec, -1
    s_lshr_b32 s22, s20, 8
    s_add_u32 s22, s22, s88
    s_add_u32 s20, s20, 13696
    s_sub_u32 s21, s21, s25
    s_add_u32 s23, s23, s25
    s_add_u32 s22, s22, s23
    s_ashr_i32 s29, s16, 8
    s_add_u32 s16, s16, s17
    s_sub_u32 s29, s21, s29
    s_waitcnt vmcnt(24)
    s_memrealtime s[58:59]
    v_mfma_f32_16x16x32_bf16 v[40:43], v[120:123], v[72:75], 0
    v_mfma_f32_16x16x32_bf16 v[44:47], v[128:131], v[72:75], 0
    v_mfma_f32_16x16x32_bf16 v[40:43], v[124:127], v[76:79], v[40:43]
    v_mfma_f32_16x16x32_bf16 v[44:47], v[132:135], v[76:79], v[44:47]
    v_mfma_f32_16x16x32_bf16 v[40:43], v[136:139], v[80:83], v[40:43]
    v_mfma_f32_16x16x32_bf16 v[44:47], v[144:147], v[80:83], v[44:47]
    v_mfma_f32_16x16x32_bf16 v[40:43], v[140:143], v[84:87], v[40:43]
    v_mfma_f32_16x16x32_bf16 v[44:47], v[148:151], v[84:87], v[44:47]
    s_add_u32 s42, s42, 1
    s_waitcnt lgkmcnt(0)
    s_sub_u32 s22, s58, s22
    s_ashr_i32 s22, s22, 2
    s_add_u32 s23, s23, s22
    s_add_u32 s22, s23, s29
    s_cmp_gt_i32 s22, s18
    s_cselect_b64 s[32:33], s[40:41], 0
    s_cselect_b32 s25, -14, 0
    s_cmp_lt_i32 s22, s19
    s_cselect_b64 s[32:33], s[60:61], s[32:33]
    s_cselect_b32 s25, 25, s25
    v_cndmask_b32 v26, v3, v4, s[32:33]
    v_cndmask_b32 v27, v4, v3, s[32:33]
    s_add_u32 s21, s21, s25
    buffer_load_dwordx4 v[120:123], v26, s[8:11], s53 offen offset:0 nt
    buffer_load_dwordx4 v[124:127], v27, s[8:11], s53 offen offset:0 nt
    buffer_load_dwordx4 v[128:131], v26, s[8:11], s53 offen offset:512 nt
    buffer_load_dwordx4 v[132:135], v27, s[8:11], s53 offen offset:512 nt
    buffer_load_dwordx4 v[136:139], v26, s[8:11], s53 offen offset:1024 nt
    buffer_load_dwordx4 v[140:143], v27, s[8:11], s53 offen offset:1024 nt
    buffer_load_dwordx4 v[144:147], v26, s[8:11], s53 offen offset:1536 nt
    buffer_load_dwordx4 v[148:151], v27, s[8:11], s53 offen offset:1536 nt
    v_mov_b32_dpp v9, v40 quad_perm:[0,0,0,0] row_mask:0xf bank_mask:0xf
    v_mov_b32_dpp v10, v44 quad_perm:[0,0,0,0] row_mask:0xf bank_mask:0xf
    v_add_f32_dpp v9, v41, v9 quad_perm:[1,1,1,1] row_mask:0xf bank_mask:0xf
    v_add_f32_dpp v10, v45, v10 quad_perm:[1,1,1,1] row_mask:0xf bank_mask:0xf
    v_add_f32_dpp v9, v42, v9 quad_perm:[2,2,2,2] row_mask:0xf bank_mask:0xf
    v_add_f32_dpp v10, v46, v10 quad_perm:[2,2,2,2] row_mask:0xf bank_mask:0xf
    v_add_f32_dpp v9, v43, v9 quad_perm:[3,3,3,3] row_mask:0xf bank_mask:0xf
    v_add_f32_dpp v10, v47, v10 quad_perm:[3,3,3,3] row_mask:0xf bank_mask:0xf
    v_cvt_pk_bf16_f32 v30, v9, v10
    v_max3_f32 v7, v9, v10, v7
    ds_write_b32 v23, v30 offset:64
    v_mov_b32 v28, s28
    v_mov_b32 v29, s23
    ds_write_b64 v15, v[28:29]
    s_add_u32 s28, s28, 1
    v_readlane_b32 s53, v21, s42
    s_xor_b64 exec, s[38:39], s[34:35]
    v_swap_b32 v72, v76
    v_swap_b32 v73, v77
    v_swap_b32 v74, v78
    v_swap_b32 v75, v79
    v_swap_b32 v80, v84
    v_swap_b32 v81, v85
    v_swap_b32 v82, v86
    v_swap_b32 v83, v87
    s_mov_b64 s[38:39], s[34:35]
    s_mov_b64 exec, -1
    s_lshr_b32 s22, s20, 8
    s_add_u32 s22, s22, s88
    s_add_u32 s20, s20, 13696
    s_sub_u32 s21, s21, s26
    s_add_u32 s23, s23, s26
    s_add_u32 s22, s22, s23
    s_ashr_i32 s29, s16, 8
    s_add_u32 s16, s16, s17
    s_sub_u32 s29, s21, s29
    s_waitcnt vmcnt(24)
    s_memrealtime s[58:59]
    v_mfma_f32_16x16x32_bf16 v[40:43], v[152:155], v[72:75], 0
    v_mfma_f32_16x16x32_bf16 v[44:47], v[160:163], v[72:75], 0
    v_mfma_f32_16x16x32_bf16 v[40:43], v[156:159], v[76:79], v[40:43]
    v_mfma_f32_16x16x32_bf16 v[44:47], v[164:167], v[76:79], v[44:47]
    v_mfma_f32_16x16x32_bf16 v[40:43], v[168:171], v[80:83], v[40:43]
    v_mfma_f32_16x16x32_bf16 v[44:47], v[176:179], v[80:83], v[44:47]
    v_mfma_f32_16x16x32_bf16 v[40:43], v[172:175], v[84:87], v[40:43]
    v_mfma_f32_16x16x32_bf16 v[44:47], v[180:183], v[84:87], v[44:47]
    s_add_u32 s42, s42, 1
    s_waitcnt lgkmcnt(0)
    s_sub_u32 s22, s58, s22
    s_ashr_i32 s22, s22, 2
    s_add_u32 s23, s23, s22
    s_add_u32 s22, s23, s29
    s_cmp_gt_i32 s22, s18
    s_cselect_b64 s[34:35], s[40:41], 0
    s_cselect_b32 s26, -14, 0
    s_cmp_lt_i32 s22, s19
    s_cselect_b64 s[34:35], s[60:61], s[34:35]
    s_cselect_b32 s26, 25, s26
    v_cndmask_b32 v26, v3, v4, s[34:35]
    v_cndmask_b32 v27, v4, v3, s[34:35]
    s_add_u32 s21, s21, s26
    buffer_load_dwordx4 v[152:155], v26, s[8:11], s53 offen offset:0 nt
    buffer_load_dwordx4 v[156:159], v27, s[8:11], s53 offen offset:0 nt
    buffer_load_dwordx4 v[160:163], v26, s[8:11], s53 offen offset:512 nt
    buffer_load_dwordx4 v[164:167], v27, s[8:11], s53 offen offset:512 nt
    buffer_load_dwordx4 v[168:171], v26, s[8:11], s53 offen offset:1024 nt
    buffer_load_dwordx4 v[172:175], v27, s[8:11], s53 offen offset:1024 nt
    buffer_load_dwordx4 v[176:179], v26, s[8:11], s53 offen offset:1536 nt
    buffer_load_dwordx4 v[180:183], v27, s[8:11], s53 offen offset:1536 nt
    v_mov_b32_dpp v9, v40 quad_perm:[0,0,0,0] row_mask:0xf bank_mask:0xf
    v_mov_b32_dpp v10, v44 quad_perm:[0,0,0,0] row_mask:0xf bank_mask:0xf
    v_add_f32_dpp v9, v41, v9 quad_perm:[1,1,1,1] row_mask:0xf bank_mask:0xf
    v_add_f32_dpp v10, v45, v10 quad_perm:[1,1,1,1] row_mask:0xf bank_mask:0xf
    v_add_f32_dpp v9, v42, v9 quad_perm:[2,2,2,2] row_mask:0xf bank_mask:0xf
    v_add_f32_dpp v10, v46, v10 quad_perm:[2,2,2,2] row_mask:0xf bank_mask:0xf
    v_add_f32_dpp v9, v43, v9 quad_perm:[3,3,3,3] row_mask:0xf bank_mask:0xf
    v_add_f32_dpp v10, v47, v10 quad_perm:[3,3,3,3] row_mask:0xf bank_mask:0xf
    v_cvt_pk_bf16_f32 v30, v9, v10
    v_max3_f32 v7, v9, v10, v7
    ds_write_b32 v23, v30 offset:128
    v_mov_b32 v28, s28
    v_mov_b32 v29, s23
    ds_write_b64 v15, v[28:29]
    s_add_u32 s28, s28, 1
    v_readlane_b32 s53, v21, s42
    s_xor_b64 exec, s[38:39], s[36:37]
    v_swap_b32 v72, v76
    v_swap_b32 v73, v77
    v_swap_b32 v74, v78
    v_swap_b32 v75, v79
    v_swap_b32 v80, v84
    v_swap_b32 v81, v85
    v_swap_b32 v82, v86
    v_swap_b32 v83, v87
    s_mov_b64 s[38:39], s[36:37]
    s_mov_b64 exec, -1
    s_lshr_b32 s22, s20, 8
    s_add_u32 s22, s22, s88
    s_add_u32 s20, s20, 13696
    s_sub_u32 s21, s21, s27
    s_add_u32 s23, s23, s27
    s_add_u32 s22, s22, s23
    s_ashr_i32 s29, s16, 8
    s_add_u32 s16, s16, s17
    s_sub_u32 s29, s21, s29
    s_waitcnt vmcnt(24)
    s_memrealtime s[58:59]
    v_mfma_f32_16x16x32_bf16 v[40:43], v[184:187], v[72:75], 0
    v_mfma_f32_16x16x32_bf16 v[44:47], v[192:195], v[72:75], 0
    v_mfma_f32_16x16x32_bf16 v[40:43], v[188:191], v[76:79], v[40:43]
    v_mfma_f32_16x16x32_bf16 v[44:47], v[196:199], v[76:79], v[44:47]
    v_mfma_f32_16x16x32_bf16 v[40:43], v[200:203], v[80:83], v[40:43]
    v_mfma_f32_16x16x32_bf16 v[44:47], v[208:211], v[80:83], v[44:47]
    v_mfma_f32_16x16x32_bf16 v[40:43], v[204:207], v[84:87], v[40:43]
    v_mfma_f32_16x16x32_bf16 v[44:47], v[212:215], v[84:87], v[44:47]
    s_add_u32 s42, s42, 1
    s_waitcnt lgkmcnt(0)
    s_sub_u32 s22, s58, s22
    s_ashr_i32 s22, s22, 2
    s_add_u32 s23, s23, s22
    s_add_u32 s22, s23, s29
    s_cmp_gt_i32 s22, s18
    s_cselect_b64 s[36:37], s[40:41], 0
    s_cselect_b32 s27, -14, 0
    s_cmp_lt_i32 s22, s19
    s_cselect_b64 s[36:37], s[60:61], s[36:37]
    s_cselect_b32 s27, 25, s27
    v_cndmask_b32 v26, v3, v4, s[36:37]
    v_cndmask_b32 v27, v4, v3, s[36:37]
    s_add_u32 s21, s21, s27
    buffer_load_dwordx4 v[184:187], v26, s[8:11], s53 offen offset:0 nt
    buffer_load_dwordx4 v[188:191], v27, s[8:11], s53 offen offset:0 nt
    buffer_load_dwordx4 v[192:195], v26, s[8:11], s53 offen offset:512 nt
    buffer_load_dwordx4 v[196:199], v27, s[8:11], s53 offen offset:512 nt
    buffer_load_dwordx4 v[200:203], v26, s[8:11], s53 offen offset:1024 nt
    buffer_load_dwordx4 v[204:207], v27, s[8:11], s53 offen offset:1024 nt
    buffer_load_dwordx4 v[208:211], v26, s[8:11], s53 offen offset:1536 nt
    buffer_load_dwordx4 v[212:215], v27, s[8:11], s53 offen offset:1536 nt
    v_mov_b32_dpp v9, v40 quad_perm:[0,0,0,0] row_mask:0xf bank_mask:0xf
    v_mov_b32_dpp v10, v44 quad_perm:[0,0,0,0] row_mask:0xf bank_mask:0xf
    v_add_f32_dpp v9, v41, v9 quad_perm:[1,1,1,1] row_mask:0xf bank_mask:0xf
    v_add_f32_dpp v10, v45, v10 quad_perm:[1,1,1,1] row_mask:0xf bank_mask:0xf
    v_add_f32_dpp v9, v42, v9 quad_perm:[2,2,2,2] row_mask:0xf bank_mask:0xf
    v_add_f32_dpp v10, v46, v10 quad_perm:[2,2,2,2] row_mask:0xf bank_mask:0xf
    v_add_f32_dpp v9, v43, v9 quad_perm:[3,3,3,3] row_mask:0xf bank_mask:0xf
    v_add_f32_dpp v10, v47, v10 quad_perm:[3,3,3,3] row_mask:0xf bank_mask:0xf
    v_cvt_pk_bf16_f32 v30, v9, v10
    v_max3_f32 v7, v9, v10, v7
    ds_write_b32 v23, v30 offset:192
    v_mov_b32 v28, s28
    v_mov_b32 v29, s23
    ds_write_b64 v15, v[28:29]
    s_add_u32 s28, s28, 1
    ds_read_b128 v[32:35], v20 offset:1088
    s_mov_b64 s[38:39], 0
    ds_read_b64 v[30:31], v24
    v_mov_b32 v23, v24
    s_nop 1
    v_max_f32_dpp v7, v7, v7 row_ror:8 row_mask:0xf bank_mask:0xf
    v_mov_b32 v9, v7
    s_nop 1
    v_permlane32_swap_b32 v7, v9
    s_nop 0
    v_max_f32 v7, v7, v9
    v_mov_b32 v9, v7
    s_nop 1
    v_permlane16_swap_b32 v7, v9
    s_nop 0
    v_max_f32 v7, v7, v9
    v_cvt_pk_bf16_f32 v7, v7, v7
    v_lshlrev_b32 v7, 16, v7
    s_mov_b32 vcc_lo, 0xaaaaaaaa
    s_mov_b32 vcc_hi, 0xaaaaaaaa
    v_readlane_b32 s44, v7, 0
    v_readlane_b32 s45, v7, 4
    s_nop 1
    v_mov_b32 v7, s44
    v_mov_b32 v9, s45
    v_cndmask_b32 v7, v7, v9, vcc
    v_mul_f32 v12, s47, v7
st_loopV_2:
    s_waitcnt lgkmcnt(0)
    v_readfirstlane_b32 s16, v32
    v_readfirstlane_b32 s17, v33
    v_readfirstlane_b32 s18, v34
    v_readfirstlane_b32 s19, v35
    s_mul_i32 s29, s17, s28
    s_add_u32 s16, s16, s29
    s_waitcnt lgkmcnt(0)
    v_lshlrev_b32 v40, 16, v30
    v_and_b32 v41, 0xffff0000, v30
    v_lshlrev_b32 v42, 16, v31
    v_and_b32 v43, 0xffff0000, v31
    ds_read_b64 v[30:31], v23 offset:64
    v_fma_f32 v44, v40, s47, -v12
    v_fma_f32 v45, v41, s47, -v12
    v_fma_f32 v46, v42, s47, -v12
    v_fma_f32 v47, v43, s47, -v12
    v_exp_f32 v44, v44
    v_exp_f32 v45, v45
    v_exp_f32 v46, v46
    v_exp_f32 v47, v47
    v_readlane_b32 s53, v21, s42
    v_cvt_pk_bf16_f32 v44, v44, v44
    v_cvt_pk_bf16_f32 v45, v45, v45
    v_cvt_pk_bf16_f32 v46, v46, v46
    v_cvt_pk_bf16_f32 v47, v47, v47
    v_and_b32 v56, v44, v36
    v_and_b32 v57, v44, v37
    v_and_b32 v58, v44, v38
    v_and_b32 v59, v44, v39
    v_and_b32 v60, v45, v36
    v_and_b32 v61, v45, v37
    v_and_b32 v62, v45, v38
    v_and_b32 v63, v45, v39
    v_and_b32 v64, v46, v36
    v_and_b32 v65, v46, v37
    v_and_b32 v66, v46, v38
    v_and_b32 v67, v46, v39
    v_and_b32 v68, v47, v36
    v_and_b32 v69, v47, v37
    v_and_b32 v70, v47, v38
    v_and_b32 v71, v47, v39
    s_xor_b64 exec, s[38:39], s[30:31]
    v_swap_b32 v48, v52
    v_swap_b32 v49, v53
    v_swap_b32 v50, v54
    v_swap_b32 v51, v55
    s_mov_b64 s[38:39], s[30:31]
    s_mov_b64 exec, -1
    s_lshr_b32 s22, s20, 8
    s_add_u32 s22, s22, s88
    s_add_u32 s20, s20, 13696
    s_sub_u32 s21, s21, s24
    s_add_u32 s23, s23, s24
    s_add_u32 s22, s22, s23
    s_ashr_i32 s29, s16, 8
    s_add_u32 s16, s16, s17
    s_sub_u32 s29, s21, s29
    s_waitcnt vmcnt(24)
    s_memrealtime s[58:59]
    s_add_u32 s42, s42, 1
    v_mfma_f32_16x16x32_bf16 v[48:51], v[56:59], v[88:91], v[48:51]
    v_mfma_f32_16x16x32_bf16 v[52:55], v[56:59], v[92:95], v[52:55]
    v_mfma_f32_16x16x32_bf16 v[48:51], v[60:63], v[96:99], v[48:51]
    v_mfma_f32_16x16x32_bf16 v[52:55], v[60:63], v[100:103], v[52:55]
    v_mfma_f32_16x16x32_bf16 v[48:51], v[64:67], v[104:107], v[48:51]
    v_mfma_f32_16x16x32_bf16 v[52:55], v[64:67], v[108:111], v[52:55]
    v_mfma_f32_16x16x32_bf16 v[48:51], v[68:71], v[112:115], v[48:51]
    v_mfma_f32_16x16x32_bf16 v[52:55], v[68:71], v[116:119], v[52:55]
    s_waitcnt lgkmcnt(0)
    s_sub_u32 s22, s58, s22
    s_ashr_i32 s22, s22, 2
    s_add_u32 s23, s23, s22
    s_add_u32 s22, s23, s29
    s_cmp_gt_i32 s22, s18
    s_cselect_b64 s[30:31], s[40:41], 0
    s_cselect_b32 s24, -14, 0
    s_cmp_lt_i32 s22, s19
    s_cselect_b64 s[30:31], s[60:61], s[30:31]
    s_cselect_b32 s24, 25, s24
    v_cndmask_b32 v26, v3, v4, s[30:31]
    v_cndmask_b32 v27, v4, v3, s[30:31]
    s_add_u32 s21, s21, s24
    buffer_load_dwordx4 v[88:91], v26, s[8:11], s53 offen offset:0 nt
    buffer_load_dwordx4 v[92:95], v27, s[8:11], s53 offen offset:0 nt
    buffer_load_dwordx4 v[96:99], v26, s[8:11], s53 offen offset:512 nt
    buffer_load_dwordx4 v[100:103], v27, s[8:11], s53 offen offset:512 nt
    buffer_load_dwordx4 v[104:107], v26, s[8:11], s53 offen offset:1024 nt
    buffer_load_dwordx4 v[108:111], v27, s[8:11], s53 offen offset:1024 nt
    buffer_load_dwordx4 v[112:115], v26, s[8:11], s53 offen offset:1536 nt
    buffer_load_dwordx4 v[116:119], v27, s[8:11], s53 offen offset:1536 nt
    v_mov_b32 v28, s28
    v_mov_b32 v29, s23
    ds_write_b64 v15, v[28:29]
    s_add_u32 s28, s28, 1
    s_waitcnt lgkmcnt(0)
    v_lshlrev_b32 v40, 16, v30
    v_and_b32 v41, 0xffff0000, v30
    v_lshlrev_b32 v42, 16, v31
    v_and_b32 v43, 0xffff0000, v31
    ds_read_b64 v[30:31], v23 offset:128
    v_fma_f32 v44, v40, s47, -v12
    v_fma_f32 v45, v41, s47, -v12
    v_fma_f32 v46, v42, s47, -v12
    v_fma_f32 v47, v43, s47, -v12
    v_exp_f32 v44, v44
    v_exp_f32 v45, v45
    v_exp_f32 v46, v46
    v_exp_f32 v47, v47
    v_readlane_b32 s53, v21, s42
    v_cvt_pk_bf16_f32 v44, v44, v44
    v_cvt_pk_bf16_f32 v45, v45, v45
    v_cvt_pk_bf16_f32 v46, v46, v46
    v_cvt_pk_bf16_f32 v47, v47, v47
    v_and_b32 v56, v44, v36
    v_and_b32 v57, v44, v37
    v_and_b32 v58, v44, v38
    v_and_b32 v59, v44, v39
    v_and_b32 v60, v45, v36
    v_and_b32 v61, v45, v37
    v_and_b32 v62, v45, v38
    v_and_b32 v63, v45, v39
    v_and_b32 v64, v46, v36
    v_and_b32 v65, v46, v37
    v_and_b32 v66, v46, v38
    v_and_b32 v67, v46, v39
    v_and_b32 v68, v47, v36
    v_and_b32 v69, v47, v37
    v_and_b32 v70, v47, v38
    v_and_b32 v71, v47, v39
    s_xor_b64 exec, s[38:39], s[32:33]
    v_swap_b32 v48, v52
    v_swap_b32 v49, v53
    v_swap_b32 v50, v54
    v_swap_b32 v51, v55
    s_mov_b64 s[38:39], s[32:33]
    s_mov_b64 exec, -1
    s_lshr_b32 s22, s20, 8
    s_add_u32 s22, s22, s88
    s_add_u32 s20, s20, 13696
    s_sub_u32 s21, s21, s25
    s_add_u32 s23, s23, s25
    s_add_u32 s22, s22, s23
    s_ashr_i32 s29, s16, 8
    s_add_u32 s16, s16, s17
    s_sub_u32 s29, s21, s29
    s_waitcnt vmcnt(24)
    s_memrealtime s[58:59]
    s_add_u32 s42, s42, 1
    v_mfma_f32_16x16x32_bf16 v[48:51], v[56:59], v[120:123], v[48:51]
    v_mfma_f32_16x16x32_bf16 v[52:55], v[56:59], v[124:127], v[52:55]
    v_mfma_f32_16x16x32_bf16 v[48:51], v[60:63], v[128:131], v[48:51]
    v_mfma_f32_16x16x32_bf16 v[52:55], v[60:63], v[132:135], v[52:55]
    v_mfma_f32_16x16x32_bf16 v[48:51], v[64:67], v[136:139], v[48:51]
    v_mfma_f32_16x16x32_bf16 v[52:55], v[64:67], v[140:143], v[52:55]
    v_mfma_f32_16x16x32_bf16 v[48:51], v[68:71], v[144:147], v[48:51]
    v_mfma_f32_16x16x32_bf16 v[52:55], v[68:71], v[148:151], v[52:55]
    s_waitcnt lgkmcnt(0)
    s_sub_u32 s22, s58, s22
    s_ashr_i32 s22, s22, 2
    s_add_u32 s23, s23, s22
    s_add_u32 s22, s23, s29
    s_cmp_gt_i32 s22, s18
    s_cselect_b64 s[32:33], s[40:41], 0
    s_cselect_b32 s25, -14, 0
    s_cmp_lt_i32 s22, s19
    s_cselect_b64 s[32:33], s[60:61], s[32:33]
    s_cselect_b32 s25, 25, s25
    v_cndmask_b32 v26, v3, v4, s[32:33]
    v_cndmask_b32 v27, v4, v3, s[32:33]
    s_add_u32 s21, s21, s25
    buffer_load_dwordx4 v[120:123], v26, s[8:11], s53 offen offset:0 nt
    buffer_load_dwordx4 v[124:127], v27, s[8:11], s53 offen offset:0 nt
    buffer_load_dwordx4 v[128:131], v26, s[8:11], s53 offen offset:512 nt
    buffer_load_dwordx4 v[132:135], v27, s[8:11], s53 offen offset:512 nt
    buffer_load_dwordx4 v[136:139], v26, s[8:11], s53 offen offset:1024 nt
    buffer_load_dwordx4 v[140:143], v27, s[8:11], s53 offen offset:1024 nt
    buffer_load_dwordx4 v[144:147], v26, s[8:11], s53 offen offset:1536 nt
    buffer_load_dwordx4 v[148:151], v27, s[8:11], s53 offen offset:1536 nt
    v_mov_b32 v28, s28
    v_mov_b32 v29, s23
    ds_write_b64 v15, v[28:29]
    s_add_u32 s28, s28, 1
    s_waitcnt lgkmcnt(0)
    v_lshlrev_b32 v40, 16, v30
    v_and_b32 v41, 0xffff0000, v30
    v_lshlrev_b32 v42, 16, v31
    v_and_b32 v43, 0xffff0000, v31
    ds_read_b64 v[30:31], v23 offset:192
    v_fma_f32 v44, v40, s47, -v12
    v_fma_f32 v45, v41, s47, -v12
    v_fma_f32 v46, v42, s47, -v12
    v_fma_f32 v47, v43, s47, -v12
    v_exp_f32 v44, v44
    v_exp_f32 v45, v45
    v_exp_f32 v46, v46
    v_exp_f32 v47, v47
    v_readlane_b32 s53, v21, s42
    v_cvt_pk_bf16_f32 v44, v44, v44
    v_cvt_pk_bf16_f32 v45, v45, v45
    v_cvt_pk_bf16_f32 v46, v46, v46
    v_cvt_pk_bf16_f32 v47, v47, v47
    v_and_b32 v56, v44, v36
    v_and_b32 v57, v44, v37
    v_and_b32 v58, v44, v38
    v_and_b32 v59, v44, v39
    v_and_b32 v60, v45, v36
    v_and_b32 v61, v45, v37
    v_and_b32 v62, v45, v38
    v_and_b32 v63, v45, v39
    v_and_b32 v64, v46, v36
    v_and_b32 v65, v46, v37
    v_and_b32 v66, v46, v38
    v_and_b32 v67, v46, v39
    v_and_b32 v68, v47, v36
    v_and_b32 v69, v47, v37
    v_and_b32 v70, v47, v38
    v_and_b32 v71, v47, v39
    s_xor_b64 exec, s[38:39], s[34:35]
    v_swap_b32 v48, v52
    v_swap_b32 v49, v53
    v_swap_b32 v50, v54
    v_swap_b32 v51, v55
    s_mov_b64 s[38:39], s[34:35]
    s_mov_b64 exec, -1
    s_lshr_b32 s22, s20, 8
    s_add_u32 s22, s22, s88
    s_add_u32 s20, s20, 13696
    s_sub_u32 s21, s21, s26
    s_add_u32 s23, s23, s26
    s_add_u32 s22, s22, s23
    s_ashr_i32 s29, s16, 8
    s_add_u32 s16, s16, s17
    s_sub_u32 s29, s21, s29
    s_waitcnt vmcnt(24)
    s_memrealtime s[58:59]
    s_add_u32 s42, s42, 1
    v_mfma_f32_16x16x32_bf16 v[48:51], v[56:59], v[152:155], v[48:51]
    v_mfma_f32_16x16x32_bf16 v[52:55], v[56:59], v[156:159], v[52:55]
    v_mfma_f32_16x16x32_bf16 v[48:51], v[60:63], v[160:163], v[48:51]
    v_mfma_f32_16x16x32_bf16 v[52:55], v[60:63], v[164:167], v[52:55]
    v_mfma_f32_16x16x32_bf16 v[48:51], v[64:67], v[168:171], v[48:51]
    v_mfma_f32_16x16x32_bf16 v[52:55], v[64:67], v[172:175], v[52:55]
    v_mfma_f32_16x16x32_bf16 v[48:51], v[68:71], v[176:179], v[48:51]
    v_mfma_f32_16x16x32_bf16 v[52:55], v[68:71], v[180:183], v[52:55]
    s_waitcnt lgkmcnt(0)
    s_sub_u32 s22, s58, s22
    s_ashr_i32 s22, s22, 2
    s_add_u32 s23, s23, s22
    s_add_u32 s22, s23, s29
    s_cmp_gt_i32 s22, s18
    s_cselect_b64 s[34:35], s[40:41], 0
    s_cselect_b32 s26, -14, 0
    s_cmp_lt_i32 s22, s19
    s_cselect_b64 s[34:35], s[60:61], s[34:35]
    s_cselect_b32 s26, 25, s26
    v_cndmask_b32 v26, v3, v4, s[34:35]
    v_cndmask_b32 v27, v4, v3, s[34:35]
    s_add_u32 s21, s21, s26
    buffer_load_dwordx4 v[152:155], v26, s[8:11], s53 offen offset:0 nt
    buffer_load_dwordx4 v[156:159], v27, s[8:11], s53 offen offset:0 nt
    buffer_load_dwordx4 v[160:163], v26, s[8:11], s53 offen offset:512 nt
    buffer_load_dwordx4 v[164:167], v27, s[8:11], s53 offen offset:512 nt
    buffer_load_dwordx4 v[168:171], v26, s[8:11], s53 offen offset:1024 nt
    buffer_load_dwordx4 v[172:175], v27, s[8:11], s53 offen offset:1024 nt
    buffer_load_dwordx4 v[176:179], v26, s[8:11], s53 offen offset:1536 nt
    buffer_load_dwordx4 v[180:183], v27, s[8:11], s53 offen offset:1536 nt
    v_mov_b32 v28, s28
    v_mov_b32 v29, s23
    ds_write_b64 v15, v[28:29]
    s_add_u32 s28, s28, 1
    s_waitcnt lgkmcnt(0)
    v_lshlrev_b32 v40, 16, v30
    v_and_b32 v41, 0xffff0000, v30
    v_lshlrev_b32 v42, 16, v31
    v_and_b32 v43, 0xffff0000, v31
    ds_read_b64 v[30:31], v23 offset:256
    ds_read_b128 v[32:35], v20 offset:1088
    v_fma_f32 v44, v40, s47, -v12
    v_fma_f32 v45, v41, s47, -v12
    v_fma_f32 v46, v42, s47, -v12
    v_fma_f32 v47, v43, s47, -v12
    v_exp_f32 v44, v44
    v_exp_f32 v45, v45
    v_exp_f32 v46, v46
    v_exp_f32 v47, v47
    v_readlane_b32 s53, v21, s42
    v_cvt_pk_bf16_f32 v44, v44, v44
    v_cvt_pk_bf16_f32 v45, v45, v45
    v_cvt_pk_bf16_f32 v46, v46, v46
    v_cvt_pk_bf16_f32 v47, v47, v47
    v_and_b32 v56, v44, v36
    v_and_b32 v57, v44, v37
    v_and_b32 v58, v44, v38
    v_and_b32 v59, v44, v39
    v_and_b32 v60, v45, v36
    v_and_b32 v61, v45, v37
    v_and_b32 v62, v45, v38
    v_and_b32 v63, v45, v39
    v_and_b32 v64, v46, v36
    v_and_b32 v65, v46, v37
    v_and_b32 v66, v46, v38
    v_and_b32 v67, v46, v39
    v_and_b32 v68, v47, v36
    v_and_b32 v69, v47, v37
    v_and_b32 v70, v47, v38
    v_and_b32 v71, v47, v39
    s_xor_b64 exec, s[38:39], s[36:37]
    v_swap_b32 v48, v52
    v_swap_b32 v49, v53
    v_swap_b32 v50, v54
    v_swap_b32 v51, v55
    s_mov_b64 s[38:39], s[36:37]
    s_mov_b64 exec, -1
    s_lshr_b32 s22, s20, 8
    s_add_u32 s22, s22, s88
    s_add_u32 s20, s20, 13696
    s_sub_u32 s21, s21, s27
    s_add_u32 s23, s23, s27
    s_add_u32 s22, s22, s23
    s_ashr_i32 s29, s16, 8
    s_add_u32 s16, s16, s17
    s_sub_u32 s29, s21, s29
    s_waitcnt vmcnt(24)
    s_memrealtime s[58:59]
    s_add_u32 s42, s42, 1
    v_mfma_f32_16x16x32_bf16 v[48:51], v[56:59], v[184:187], v[48:51]
    v_mfma_f32_16x16x32_bf16 v[52:55], v[56:59], v[188:191], v[52:55]
    v_mfma_f32_16x16x32_bf16 v[48:51], v[60:63], v[192:195], v[48:51]
    v_mfma_f32_16x16x32_bf16 v[52:55], v[60:63], v[196:199], v[52:55]
    v_mfma_f32_16x16x32_bf16 v[48:51], v[64:67], v[200:203], v[48:51]
    v_mfma_f32_16x16x32_bf16 v[52:55], v[64:67], v[204:207], v[52:55]
    v_mfma_f32_16x16x32_bf16 v[48:51], v[68:71], v[208:211], v[48:51]
    v_mfma_f32_16x16x32_bf16 v[52:55], v[68:71], v[212:215], v[52:55]
    s_waitcnt lgkmcnt(0)
    s_sub_u32 s22, s58, s22
    s_ashr_i32 s22, s22, 2
    s_add_u32 s23, s23, s22
    s_add_u32 s22, s23, s29
    s_cmp_gt_i32 s22, s18
    s_cselect_b64 s[36:37], s[40:41], 0
    s_cselect_b32 s27, -14, 0
    s_cmp_lt_i32 s22, s19
    s_cselect_b64 s[36:37], s[60:61], s[36:37]
    s_cselect_b32 s27, 25, s27
    v_cndmask_b32 v26, v3, v4, s[36:37]
    v_cndmask_b32 v27, v4, v3, s[36:37]
    s_add_u32 s21, s21, s27
    buffer_load_dwordx4 v[184:187], v26, s[8:11], s53 offen offset:0 nt
    buffer_load_dwordx4 v[188:191], v27, s[8:11], s53 offen offset:0 nt
    buffer_load_dwordx4 v[192:195], v26, s[8:11], s53 offen offset:512 nt
    buffer_load_dwordx4 v[196:199], v27, s[8:11], s53 offen offset:512 nt
    buffer_load_dwordx4 v[200:203], v26, s[8:11], s53 offen offset:1024 nt
    buffer_load_dwordx4 v[204:207], v27, s[8:11], s53 offen offset:1024 nt
    buffer_load_dwordx4 v[208:211], v26, s[8:11], s53 offen offset:1536 nt
    buffer_load_dwordx4 v[212:215], v27, s[8:11], s53 offen offset:1536 nt
    v_mov_b32 v28, s28
    v_mov_b32 v29, s23
    ds_write_b64 v15, v[28:29]
    s_add_u32 s28, s28, 1
    v_add_u32 v23, 256, v23
    s_cmp_lt_u32 s42, 64
    s_cbranch_scc1 st_loopV_2
    v_and_b32 v9, 1, v0
    v_lshlrev_b32 v9, 2, v9
    s_mov_b32 s54, 262144
st_zw_3:
    ds_read_b64 v[28:29], v20 offset:1064
    ds_read_b32 v10, v9 offset:1056
    s_waitcnt lgkmcnt(0)
    v_readfirstlane_b32 s56, v28
    v_readfirstlane_b32 s50, v29
    s_cmp_eq_u32 s56, s88
    s_cbranch_scc1 st_zg_4
    s_sub_u32 s54, s54, 1
    s_cbranch_scc0 st_zw_3
st_zg_4:
    v_sub_f32 v11, v12, v10
    v_exp_f32 v11, v11
    v_mov_b32 v12, v10
    s_nop 1
    v_mul_f32_dpp v48, v11, v48 quad_perm:[0,0,2,2] row_mask:0xf bank_mask:0xf
    v_mul_f32_dpp v49, v11, v49 quad_perm:[1,1,3,3] row_mask:0xf bank_mask:0xf
    v_mul_f32_dpp v50, v11, v50 quad_perm:[0,0,2,2] row_mask:0xf bank_mask:0xf
    v_mul_f32_dpp v51, v11, v51 quad_perm:[1,1,3,3] row_mask:0xf bank_mask:0xf
    v_mul_f32_dpp v52, v11, v52 quad_perm:[0,0,2,2] row_mask:0xf bank_mask:0xf
    v_mul_f32_dpp v53, v11, v53 quad_perm:[1,1,3,3] row_mask:0xf bank_mask:0xf
    v_mul_f32_dpp v54, v11, v54 quad_perm:[0,0,2,2] row_mask:0xf bank_mask:0xf
    v_mul_f32_dpp v55, v11, v55 quad_perm:[1,1,3,3] row_mask:0xf bank_mask:0xf
    s_waitcnt lgkmcnt(0)
    v_lshlrev_b32 v40, 16, v30
    v_and_b32 v41, 0xffff0000, v30
    v_lshlrev_b32 v42, 16, v31
    v_and_b32 v43, 0xffff0000, v31
    ds_read_b64 v[30:31], v23 offset:64
    v_fma_f32 v44, v40, s47, -v12
    v_fma_f32 v45, v41, s47, -v12
    v_fma_f32 v46, v42, s47, -v12
    v_fma_f32 v47, v43, s47, -v12
    v_exp_f32 v44, v44
    v_exp_f32 v45, v45
    v_exp_f32 v46, v46
    v_exp_f32 v47, v47
    s_nop 0
    v_cvt_pk_bf16_f32 v44, v44, v44
    v_cvt_pk_bf16_f32 v45, v45, v45
    v_cvt_pk_bf16_f32 v46, v46, v46
    v_cvt_pk_bf16_f32 v47, v47, v47
    v_and_b32 v56, v44, v36
    v_and_b32 v57, v44, v37
    v_and_b32 v58, v44, v38
    v_and_b32 v59, v44, v39
    v_and_b32 v60, v45, v36
    v_and_b32 v61, v45, v37
    v_and_b32 v62, v45, v38
    v_and_b32 v63, v45, v39
    v_and_b32 v64, v46, v36
    v_and_b32 v65, v46, v37
    v_and_b32 v66, v46, v38
    v_and_b32 v67, v46, v39
    v_and_b32 v68, v47, v36
    v_and_b32 v69, v47, v37
    v_and_b32 v70, v47, v38
    v_and_b32 v71, v47, v39
    s_xor_b64 exec, s[38:39], s[30:31]
    v_swap_b32 v48, v52
    v_swap_b32 v49, v53
    v_swap_b32 v50, v54
    v_swap_b32 v51, v55
    s_mov_b64 s[38:39], s[30:31]
    s_mov_b64 exec, -1
    s_waitcnt vmcnt(24)
    v_mfma_f32_16x16x32_bf16 v[48:51], v[56:59], v[88:91], v[48:51]
    v_mfma_f32_16x16x32_bf16 v[52:55], v[56:59], v[92:95], v[52:55]
    v_mfma_f32_16x16x32_bf16 v[48:51], v[60:63], v[96:99], v[48:51]
    v_mfma_f32_16x16x32_bf16 v[52:55], v[60:63], v[100:103], v[52:55]
    v_mfma_f32_16x16x32_bf16 v[48:51], v[64:67], v[104:107], v[48:51]
    v_mfma_f32_16x16x32_bf16 v[52:55], v[64:67], v[108:111], v[52:55]
    v_mfma_f32_16x16x32_bf16 v[48:51], v[68:71], v[112:115], v[48:51]
    v_mfma_f32_16x16x32_bf16 v[52:55], v[68:71], v[116:119], v[52:55]
    v_mov_b32 v28, s28
    v_mov_b32 v29, s23
    ds_write_b64 v15, v[28:29]
    s_add_u32 s28, s28, 1
    s_waitcnt lgkmcnt(0)
    v_lshlrev_b32 v40, 16, v30
    v_and_b32 v41, 0xffff0000, v30
    v_lshlrev_b32 v42, 16, v31
    v_and_b32 v43, 0xffff0000, v31
    ds_read_b64 v[30:31], v23 offset:128
    v_fma_f32 v44, v40, s47, -v12
    v_fma_f32 v45, v41, s47, -v12
    v_fma_f32 v46, v42, s47, -v12
    v_fma_f32 v47, v43, s47, -v12
    v_exp_f32 v44, v44
    v_exp_f32 v45, v45
    v_exp_f32 v46, v46
    v_exp_f32 v47, v47
    s_nop 0
    v_cvt_pk_bf16_f32 v44, v44, v44
    v_cvt_pk_bf16_f32 v45, v45, v45
    v_cvt_pk_bf16_f32 v46, v46, v46
    v_cvt_pk_bf16_f32 v47, v47, v47
    v_and_b32 v56, v44, v36
    v_and_b32 v57, v44, v37
    v_and_b32 v58, v44, v38
    v_and_b32 v59, v44, v39
    v_and_b32 v60, v45, v36
    v_and_b32 v61, v45, v37
    v_and_b32 v62, v45, v38
    v_and_b32 v63, v45, v39
    v_and_b32 v64, v46, v36
    v_and_b32 v65, v46, v37
    v_and_b32 v66, v46, v38
    v_and_b32 v67, v46, v39
    v_and_b32 v68, v47, v36
    v_and_b32 v69, v47, v37
    v_and_b32 v70, v47, v38
    v_and_b32 v71, v47, v39
    s_xor_b64 exec, s[38:39], s[32:33]
    v_swap_b32 v48, v52
    v_swap_b32 v49, v53
    v_swap_b32 v50, v54
    v_swap_b32 v51, v55
    s_mov_b64 s[38:39], s[32:33]
    s_mov_b64 exec, -1
    v_mov_b32 v89, s88
    v_mov_b32 v91, s89
    v_mov_b32 v93, s88
    v_mov_b32 v95, s89
    v_mov_b32 v97, s88
    v_mov_b32 v99, s89
    v_mov_b32 v101, s88
    v_mov_b32 v103, s89
    s_waitcnt vmcnt(16)
    v_mfma_f32_16x16x32_bf16 v[48:51], v[56:59], v[120:123], v[48:51]
    v_mfma_f32_16x16x32_bf16 v[52:55], v[56:59], v[124:127], v[52:55]
    v_mfma_f32_16x16x32_bf16 v[48:51], v[60:63], v[128:131], v[48:51]
    v_mfma_f32_16x16x32_bf16 v[52:55], v[60:63], v[132:135], v[52:55]
    v_mfma_f32_16x16x32_bf16 v[48:51], v[64:67], v[136:139], v[48:51]
    v_mfma_f32_16x16x32_bf16 v[52:55], v[64:67], v[140:143], v[52:55]
    v_mfma_f32_16x16x32_bf16 v[48:51], v[68:71], v[144:147], v[48:51]
    v_mfma_f32_16x16x32_bf16 v[52:55], v[68:71], v[148:151], v[52:55]
    v_mov_b32 v28, s28
    v_mov_b32 v29, s23
    ds_write_b64 v15, v[28:29]
    s_add_u32 s28, s28, 1
    s_waitcnt lgkmcnt(0)
    v_lshlrev_b32 v40, 16, v30
    v_and_b32 v41, 0xffff0000, v30
    v_lshlrev_b32 v42, 16, v31
    v_and_b32 v43, 0xffff0000, v31
    ds_read_b64 v[30:31], v23 offset:192
    v_fma_f32 v44, v40, s47, -v12
    v_fma_f32 v45, v41, s47, -v12
    v_fma_f32 v46, v42, s47, -v12
    v_fma_f32 v47, v43, s47, -v12
    v_exp_f32 v44, v44
    v_exp_f32 v45, v45
    v_exp_f32 v46, v46
    v_exp_f32 v47, v47
    s_nop 0
    v_cvt_pk_bf16_f32 v44, v44, v44
    v_cvt_pk_bf16_f32 v45, v45, v45
    v_cvt_pk_bf16_f32 v46, v46, v46
    v_cvt_pk_bf16_f32 v47, v47, v47
    v_and_b32 v56, v44, v36
    v_and_b32 v57, v44, v37
    v_and_b32 v58, v44, v38
    v_and_b32 v59, v44, v39
    v_and_b32 v60, v45, v36
    v_and_b32 v61, v45, v37
    v_and_b32 v62, v45, v38
    v_and_b32 v63, v45, v39
    v_and_b32 v64, v46, v36
    v_and_b32 v65, v46, v37
    v_and_b32 v66, v46, v38
    v_and_b32 v67, v46, v39
    v_and_b32 v68, v47, v36
    v_and_b32 v69, v47, v37
    v_and_b32 v70, v47, v38
    v_and_b32 v71, v47, v39
    s_xor_b64 exec, s[38:39], s[34:35]
    v_swap_b32 v48, v52
    v_swap_b32 v49, v53
    v_swap_b32 v50, v54
    v_swap_b32 v51, v55
    s_mov_b64 s[38:39], s[34:35]
    s_mov_b64 exec, -1
    s_waitcnt vmcnt(8)
    v_mfma_f32_16x16x32_bf16 v[48:51], v[56:59], v[152:155], v[48:51]
    v_mfma_f32_16x16x32_bf16 v[52:55], v[56:59], v[156:159], v[52:55]
    v_mfma_f32_16x16x32_bf16 v[48:51], v[60:63], v[160:163], v[48:51]
    v_mfma_f32_16x16x32_bf16 v[52:55], v[60:63], v[164:167], v[52:55]
    v_mfma_f32_16x16x32_bf16 v[48:51], v[64:67], v[168:171], v[48:51]
    v_mfma_f32_16x16x32_bf16 v[52:55], v[64:67], v[172:175], v[52:55]
    v_mfma_f32_16x16x32_bf16 v[48:51], v[68:71], v[176:179], v[48:51]
    v_mfma_f32_16x16x32_bf16 v[52:55], v[68:71], v[180:183], v[52:55]
    v_mov_b32 v28, s28
    v_mov_b32 v29, s23
    ds_write_b64 v15, v[28:29]
    s_add_u32 s28, s28, 1
    s_waitcnt lgkmcnt(0)
    v_lshlrev_b32 v40, 16, v30
    v_and_b32 v41, 0xffff0000, v30
    v_lshlrev_b32 v42, 16, v31
    v_and_b32 v43, 0xffff0000, v31
    v_fma_f32 v44, v40, s47, -v12
    v_fma_f32 v45, v41, s47, -v12
    v_fma_f32 v46, v42, s47, -v12
    v_fma_f32 v47, v43, s47, -v12
    v_exp_f32 v44, v44
    v_exp_f32 v45, v45
    v_exp_f32 v46, v46
    v_exp_f32 v47, v47
    s_nop 0
    v_cvt_pk_bf16_f32 v44, v44, v44
    v_cvt_pk_bf16_f32 v45, v45, v45
    v_cvt_pk_bf16_f32 v46, v46, v46
    v_cvt_pk_bf16_f32 v47, v47, v47
    v_and_b32 v56, v44, v36
    v_and_b32 v57, v44, v37
    v_and_b32 v58, v44, v38
    v_and_b32 v59, v44, v39
    v_and_b32 v60, v45, v36
    v_and_b32 v61, v45, v37
    v_and_b32 v62, v45, v38
    v_and_b32 v63, v45, v39
    v_and_b32 v64, v46, v36
    v_and_b32 v65, v46, v37
    v_and_b32 v66, v46, v38
    v_and_b32 v67, v46, v39
    v_and_b32 v68, v47, v36
    v_and_b32 v69, v47, v37
    v_and_b32 v70, v47, v38
    v_and_b32 v71, v47, v39
    s_xor_b64 exec, s[38:39], s[36:37]
    v_swap_b32 v48, v52
    v_swap_b32 v49, v53
    v_swap_b32 v50, v54
    v_swap_b32 v51, v55
    s_mov_b64 s[38:39], s[36:37]
    s_mov_b64 exec, -1
    v_lshlrev_b32 v9, 4, v0
    s_mul_i32 s49, s2, 4224
    s_add_u32 s49, s49, 0xa0000
    v_mov_b32 v15, 1028
    s_waitcnt vmcnt(0)
    v_mfma_f32_16x16x32_bf16 v[48:51], v[56:59], v[184:187], v[48:51]
    v_mfma_f32_16x16x32_bf16 v[52:55], v[56:59], v[188:191], v[52:55]
    v_mfma_f32_16x16x32_bf16 v[48:51], v[60:63], v[192:195], v[48:51]
    v_mfma_f32_16x16x32_bf16 v[52:55], v[60:63], v[196:199], v[52:55]
    v_mfma_f32_16x16x32_bf16 v[48:51], v[64:67], v[200:203], v[48:51]
    v_mfma_f32_16x16x32_bf16 v[52:55], v[64:67], v[204:207], v[52:55]
    v_mfma_f32_16x16x32_bf16 v[48:51], v[68:71], v[208:211], v[48:51]
    v_mfma_f32_16x16x32_bf16 v[52:55], v[68:71], v[212:215], v[52:55]
    s_mov_b64 exec, 1
    ds_add_rtn_u32 v16, v15, v17 offset:8
    s_mov_b64 exec, s[38:39]
    s_nop 4
    v_swap_b32 v48, v52
    v_swap_b32 v49, v53
    v_swap_b32 v50, v54
    v_swap_b32 v51, v55
    s_mov_b64 exec, -1
    s_waitcnt lgkmcnt(0)
    v_readfirstlane_b32 s56, v16
    s_cmp_lg_u32 s56, 0
    s_cbranch_scc1 st_2nd_5
    ds_write_b128 v9, v[48:51] offset:4096
    ds_write_b128 v9, v[52:55] offset:5120
    ds_write_b32 v15, v19 offset:12
    s_branch st_b3_6
st_2nd_5:
    s_mov_b32 s54, 16384
st_w2_7:
    ds_read_b32 v16, v15 offset:12
    ds_read_b128 v[56:59], v9 offset:4096
    ds_read_b128 v[60:63], v9 offset:5120
    s_waitcnt lgkmcnt(2)
    v_readfirstlane_b32 s56, v16
    s_cmp_eq_u32 s56, s88
    s_cbranch_scc1 st_g2_8
    s_sub_u32 s54, s54, 1
    s_cbranch_scc1 st_g2_8
    s_waitcnt lgkmcnt(0)
    s_branch st_w2_7
st_g2_8:
    s_cmp_eq_u32 s50, 0
    s_cbranch_scc1 st_rem_9
    s_waitcnt lgkmcnt(1)
    v_add_f32 v88, v48, v56
    v_add_f32 v90, v49, v57
    buffer_store_dwordx4 v[88:91], v9, s[12:15], s49 offen offset:0
    v_add_f32 v92, v50, v58
    v_add_f32 v94, v51, v59
    buffer_store_dwordx4 v[92:95], v9, s[12:15], s49 offen offset:1024
    s_waitcnt lgkmcnt(0)
    v_add_f32 v96, v52, v60
    v_add_f32 v98, v53, v61
    buffer_store_dwordx4 v[96:99], v9, s[12:15], s49 offen offset:2048
    v_add_f32 v100, v54, v62
    v_add_f32 v102, v55, v63
    buffer_store_dwordx4 v[100:103], v9, s[12:15], s49 offen offset:3072
    s_branch st_b3_6
st_rem_9:
    s_waitcnt lgkmcnt(1)
    v_add_f32 v88, v48, v56
    v_add_f32 v90, v49, v57
    buffer_store_dwordx4 v[88:91], v9, s[12:15], s49 offen offset:0 sc1
    v_add_f32 v92, v50, v58
    v_add_f32 v94, v51, v59
    buffer_store_dwordx4 v[92:95], v9, s[12:15], s49 offen offset:1024 sc1
    s_waitcnt lgkmcnt(0)
    v_add_f32 v96, v52, v60
    v_add_f32 v98, v53, v61
    buffer_store_dwordx4 v[96:99], v9, s[12:15], s49 offen offset:2048 sc1
    v_add_f32 v100, v54, v62
    v_add_f32 v102, v55, v63
    buffer_store_dwordx4 v[100:103], v9, s[12:15], s49 offen offset:3072 sc1
st_b3_6:
    v_mov_b32 v9, 0
    s_endpgm
L_auxA:
    s_mov_b32 s4, s16
    s_mov_b32 s5, s17
    s_mov_b32 s6, 0x380
    s_mov_b32 s7, 0x00020000
    s_mov_b32 s8, s22
    s_mov_b32 s9, s23
    s_mov_b32 s10, 0x380000
    s_mov_b32 s11, 0x00020000
    s_lshr_b32 s54, s2, 5
    s_and_b32 s55, s2, 31
    s_and_b32 s58, s2, 3
    s_lshr_b32 s59, s2, 2
    s_lshl_b32 s59, s59, 7
    v_lshrrev_b32 v36, 3, v0
    v_mul_u32_u24 v37, 114688, v36
    v_and_b32 v38, 7, v0
    v_lshl_add_u32 v37, v38, 4, v37
    s_mul_i32 s53, s58, 917504
    s_add_u32 s53, s53, s59
    buffer_load_dwordx4 v[60:63], v37, s[8:11], s53 offen nt
    s_add_u32 s53, s53, 8192
    v_mul_u32_u24 v38, 28, v36
    s_mul_i32 s52, s58, 224
    buffer_load_dwordx4 v[12:15], v38, s[4:7], s52 offen
    buffer_load_dwordx3 v[16:18], v38, s[4:7], s52 offen offset:16
    buffer_load_dwordx4 v[64:67], v37, s[8:11], s53 offen nt
    s_add_u32 s53, s53, 8192
    buffer_load_dwordx4 v[68:71], v37, s[8:11], s53 offen nt
    s_add_u32 s53, s53, 8192
    buffer_load_dwordx4 v[72:75], v37, s[8:11], s53 offen nt
    s_add_u32 s53, s53, 8192
    buffer_load_dwordx4 v[76:79], v37, s[8:11], s53 offen nt
    s_add_u32 s53, s53, 8192
    buffer_load_dwordx4 v[80:83], v37, s[8:11], s53 offen nt
    s_add_u32 s53, s53, 8192
    buffer_load_dwordx4 v[84:87], v37, s[8:11], s53 offen nt
    s_add_u32 s53, s53, 8192
    buffer_load_dwordx4 v[88:91], v37, s[8:11], s53 offen nt
    s_add_u32 s53, s53, 8192
    buffer_load_dwordx4 v[92:95], v37, s[8:11], s53 offen nt
    s_add_u32 s53, s53, 8192
    buffer_load_dwordx4 v[96:99], v37, s[8:11], s53 offen nt
    s_add_u32 s53, s53, 8192
    buffer_load_dwordx4 v[100:103], v37, s[8:11], s53 offen nt
    s_add_u32 s53, s53, 8192
    buffer_load_dwordx4 v[104:107], v37, s[8:11], s53 offen nt
    s_add_u32 s53, s53, 8192
    buffer_load_dwordx4 v[108:111], v37, s[8:11], s53 offen nt
    s_add_u32 s53, s53, 8192
    buffer_load_dwordx4 v[112:115], v37, s[8:11], s53 offen nt
    s_barrier
    s_mov_b32 s44, s38
    s_mov_b32 s45, s39
    s_mov_b32 s46, 0x100
    s_mov_b32 s47, 0x00020000
    s_mov_b32 s48, s24
    s_mov_b32 s49, s25
    s_mov_b32 s50, 0x380000
    s_mov_b32 s51, 0x00020000
    s_mov_b64 s[42:43], s[36:37]
    v_mov_b32 v38, 0
    buffer_load_dword v39, v38, s[44:47], 0 offen sc1
    s_waitcnt vmcnt(13)
    v_perm_b32 v28, v64, v60, s60
    v_perm_b32 v29, v64, v60, s61
    v_perm_b32 v30, v65, v61, s60
    v_perm_b32 v31, v65, v61, s61
    v_perm_b32 v32, v66, v62, s60
    v_perm_b32 v33, v66, v62, s61
    v_perm_b32 v34, v67, v63, s60
    v_perm_b32 v35, v67, v63, s61
    v_dot2_f32_bf16 v20, v28, v12, 0
    v_dot2_f32_bf16 v21, v29, v12, 0
    v_dot2_f32_bf16 v22, v30, v12, 0
    v_dot2_f32_bf16 v23, v31, v12, 0
    v_dot2_f32_bf16 v24, v32, v12, 0
    v_dot2_f32_bf16 v25, v33, v12, 0
    v_dot2_f32_bf16 v26, v34, v12, 0
    v_dot2_f32_bf16 v27, v35, v12, 0
    s_waitcnt vmcnt(11)
    v_perm_b32 v28, v72, v68, s60
    v_perm_b32 v29, v72, v68, s61
    v_perm_b32 v30, v73, v69, s60
    v_perm_b32 v31, v73, v69, s61
    v_perm_b32 v32, v74, v70, s60
    v_perm_b32 v33, v74, v70, s61
    v_perm_b32 v34, v75, v71, s60
    v_perm_b32 v35, v75, v71, s61
    v_dot2_f32_bf16 v20, v28, v13, v20
    v_dot2_f32_bf16 v21, v29, v13, v21
    v_dot2_f32_bf16 v22, v30, v13, v22
    v_dot2_f32_bf16 v23, v31, v13, v23
    v_dot2_f32_bf16 v24, v32, v13, v24
    v_dot2_f32_bf16 v25, v33, v13, v25
    v_dot2_f32_bf16 v26, v34, v13, v26
    v_dot2_f32_bf16 v27, v35, v13, v27
    s_waitcnt vmcnt(9)
    v_perm_b32 v28, v80, v76, s60
    v_perm_b32 v29, v80, v76, s61
    v_perm_b32 v30, v81, v77, s60
    v_perm_b32 v31, v81, v77, s61
    v_perm_b32 v32, v82, v78, s60
    v_perm_b32 v33, v82, v78, s61
    v_perm_b32 v34, v83, v79, s60
    v_perm_b32 v35, v83, v79, s61
    v_dot2_f32_bf16 v20, v28, v14, v20
    v_dot2_f32_bf16 v21, v29, v14, v21
    v_dot2_f32_bf16 v22, v30, v14, v22
    v_dot2_f32_bf16 v23, v31, v14, v23
    v_dot2_f32_bf16 v24, v32, v14, v24
    v_dot2_f32_bf16 v25, v33, v14, v25
    v_dot2_f32_bf16 v26, v34, v14, v26
    v_dot2_f32_bf16 v27, v35, v14, v27
    s_waitcnt vmcnt(7)
    v_perm_b32 v28, v88, v84, s60
    v_perm_b32 v29, v88, v84, s61
    v_perm_b32 v30, v89, v85, s60
    v_perm_b32 v31, v89, v85, s61
    v_perm_b32 v32, v90, v86, s60
    v_perm_b32 v33, v90, v86, s61
    v_perm_b32 v34, v91, v87, s60
    v_perm_b32 v35, v91, v87, s61
    v_dot2_f32_bf16 v20, v28, v15, v20
    v_dot2_f32_bf16 v21, v29, v15, v21
    v_dot2_f32_bf16 v22, v30, v15, v22
    v_dot2_f32_bf16 v23, v31, v15, v23
    v_dot2_f32_bf16 v24, v32, v15, v24
    v_dot2_f32_bf16 v25, v33, v15, v25
    v_dot2_f32_bf16 v26, v34, v15, v26
    v_dot2_f32_bf16 v27, v35, v15, v27
    s_waitcnt vmcnt(5)
    v_perm_b32 v28, v96, v92, s60
    v_perm_b32 v29, v96, v92, s61
    v_perm_b32 v30, v97, v93, s60
    v_perm_b32 v31, v97, v93, s61
    v_perm_b32 v32, v98, v94, s60
    v_perm_b32 v33, v98, v94, s61
    v_perm_b32 v34, v99, v95, s60
    v_perm_b32 v35, v99, v95, s61
    v_dot2_f32_bf16 v20, v28, v16, v20
    v_dot2_f32_bf16 v21, v29, v16, v21
    v_dot2_f32_bf16 v22, v30, v16, v22
    v_dot2_f32_bf16 v23, v31, v16, v23
    v_dot2_f32_bf16 v24, v32, v16, v24
    v_dot2_f32_bf16 v25, v33, v16, v25
    v_dot2_f32_bf16 v26, v34, v16, v26
    v_dot2_f32_bf16 v27, v35, v16, v27
    s_waitcnt vmcnt(3)
    v_perm_b32 v28, v104, v100, s60
    v_perm_b32 v29, v104, v100, s61
    v_perm_b32 v30, v105, v101, s60
    v_perm_b32 v31, v105, v101, s61
    v_perm_b32 v32, v106, v102, s60
    v_perm_b32 v33, v106, v102, s61
    v_perm_b32 v34, v107, v103, s60
    v_perm_b32 v35, v107, v103, s61
    v_dot2_f32_bf16 v20, v28, v17, v20
    v_dot2_f32_bf16 v21, v29, v17, v21
    v_dot2_f32_bf16 v22, v30, v17, v22
    v_dot2_f32_bf16 v23, v31, v17, v23
    v_dot2_f32_bf16 v24, v32, v17, v24
    v_dot2_f32_bf16 v25, v33, v17, v25
    v_dot2_f32_bf16 v26, v34, v17, v26
    v_dot2_f32_bf16 v27, v35, v17, v27
    s_waitcnt vmcnt(1)
    v_perm_b32 v28, v112, v108, s60
    v_perm_b32 v29, v112, v108, s61
    v_perm_b32 v30, v113, v109, s60
    v_perm_b32 v31, v113, v109, s61
    v_perm_b32 v32, v114, v110, s60
    v_perm_b32 v33, v114, v110, s61
    v_perm_b32 v34, v115, v111, s60
    v_perm_b32 v35, v115, v111, s61
    v_dot2_f32_bf16 v20, v28, v18, v20
    v_dot2_f32_bf16 v21, v29, v18, v21
    v_dot2_f32_bf16 v22, v30, v18, v22
    v_dot2_f32_bf16 v23, v31, v18, v23
    v_dot2_f32_bf16 v24, v32, v18, v24
    v_dot2_f32_bf16 v25, v33, v18, v25
    v_dot2_f32_bf16 v26, v34, v18, v26
    v_dot2_f32_bf16 v27, v35, v18, v27
    s_nop 2
    v_add_f32_dpp v20, v20, v20 row_ror:8 row_mask:0xf bank_mask:0xf
    v_add_f32_dpp v21, v21, v21 row_ror:8 row_mask:0xf bank_mask:0xf
    v_add_f32_dpp v22, v22, v22 row_ror:8 row_mask:0xf bank_mask:0xf
    v_add_f32_dpp v23, v23, v23 row_ror:8 row_mask:0xf bank_mask:0xf
    v_add_f32_dpp v24, v24, v24 row_ror:8 row_mask:0xf bank_mask:0xf
    v_add_f32_dpp v25, v25, v25 row_ror:8 row_mask:0xf bank_mask:0xf
    v_add_f32_dpp v26, v26, v26 row_ror:8 row_mask:0xf bank_mask:0xf
    v_add_f32_dpp v27, v27, v27 row_ror:8 row_mask:0xf bank_mask:0xf
    v_mov_b32 v28, v20
    v_mov_b32 v29, v21
    v_mov_b32 v30, v22
    v_mov_b32 v31, v23
    v_mov_b32 v32, v24
    v_mov_b32 v33, v25
    v_mov_b32 v34, v26
    v_mov_b32 v35, v27
    s_nop 1
    v_permlane16_swap_b32 v20, v28
    v_permlane16_swap_b32 v21, v29
    v_permlane16_swap_b32 v22, v30
    v_permlane16_swap_b32 v23, v31
    v_permlane16_swap_b32 v24, v32
    v_permlane16_swap_b32 v25, v33
    v_permlane16_swap_b32 v26, v34
    v_permlane16_swap_b32 v27, v35
    v_add_f32 v20, v20, v28
    v_add_f32 v21, v21, v29
    v_add_f32 v22, v22, v30
    v_add_f32 v23, v23, v31
    v_add_f32 v24, v24, v32
    v_add_f32 v25, v25, v33
    v_add_f32 v26, v26, v34
    v_add_f32 v27, v27, v35
    v_mov_b32 v28, v20
    v_mov_b32 v29, v21
    v_mov_b32 v30, v22
    v_mov_b32 v31, v23
    v_mov_b32 v32, v24
    v_mov_b32 v33, v25
    v_mov_b32 v34, v26
    v_mov_b32 v35, v27
    s_nop 1
    v_permlane32_swap_b32 v20, v28
    v_permlane32_swap_b32 v21, v29
    v_permlane32_swap_b32 v22, v30
    v_permlane32_swap_b32 v23, v31
    v_permlane32_swap_b32 v24, v32
    v_permlane32_swap_b32 v25, v33
    v_permlane32_swap_b32 v26, v34
    v_permlane32_swap_b32 v27, v35
    v_add_f32 v20, v20, v28
    v_add_f32 v21, v21, v29
    v_add_f32 v22, v22, v30
    v_add_f32 v23, v23, v31
    v_add_f32 v24, v24, v32
    v_add_f32 v25, v25, v33
    v_add_f32 v26, v26, v34
    v_add_f32 v27, v27, v35
    v_lshlrev_b32 v36, 4, v0
    s_lshl_b32 s52, s54, 14
    s_lshl_b32 s53, s58, 12
    s_add_u32 s53, s53, s52
    s_and_b32 s57, s59, 0x380
    s_lshl_b32 s57, s57, 2
    s_add_u32 s53, s53, s57
    s_mov_b32 s56, 16384
ptag_10:
    s_waitcnt vmcnt(0)
    v_readfirstlane_b32 s88, v39
    s_cmp_lg_u32 s88, 0
    s_cbranch_scc1 ptag_done_11
    s_sub_u32 s56, s56, 1
    s_cbranch_scc1 ptag_done_11
    s_sleep 1
    buffer_load_dword v39, v38, s[44:47], 0 offen sc1
    s_branch ptag_10
ptag_done_11:
    s_mul_i32 s89, s88, 0x9e3779b1
    s_add_u32 s89, s89, 0x7f4a7c15
    v_mov_b32 v44, v20
    v_mov_b32 v45, s88
    v_mov_b32 v46, v21
    v_mov_b32 v47, s89
    v_mov_b32 v48, v22
    v_mov_b32 v49, s88
    v_mov_b32 v50, v23
    v_mov_b32 v51, s89
    v_mov_b32 v52, v24
    v_mov_b32 v53, s88
    v_mov_b32 v54, v25
    v_mov_b32 v55, s89
    v_mov_b32 v56, v26
    v_mov_b32 v57, s88
    v_mov_b32 v58, v27
    v_mov_b32 v59, s89
    s_mov_b64 exec, 0xff
    buffer_store_dwordx4 v[44:47], v36, s[12:15], s53 offen offset:0 sc1
    buffer_store_dwordx4 v[48:51], v36, s[12:15], s53 offen offset:128 sc1
    buffer_store_dwordx4 v[52:55], v36, s[12:15], s53 offen offset:256 sc1
    buffer_store_dwordx4 v[56:59], v36, s[12:15], s53 offen offset:384 sc1
    s_mov_b64 exec, -1
    v_lshrrev_b32 v37, 5, v0
    v_lshlrev_b32 v37, 7, v37
    v_and_b32 v4, 7, v0
    v_lshl_add_u32 v37, v4, 4, v37
    v_bfe_u32 v4, v0, 3, 2
    v_lshl_add_u32 v37, v4, 2, v37
    s_add_u32 s81, s52, 4096
    s_add_u32 s82, s52, 8192
    s_add_u32 s83, s52, 12288
    v_mov_b32 v220, 0
    v_mov_b32 v221, 0
    v_mov_b32 v222, 0x7fffffff
    v_mov_b32 v223, 0x80000000
    s_sleep 40
    s_mov_b32 s56, 16384
    buffer_load_dwordx4 v[60:63], v36, s[12:15], s52 offen offset:0 sc1
    buffer_load_dwordx4 v[64:67], v36, s[12:15], s52 offen offset:1024 sc1
    buffer_load_dwordx4 v[68:71], v36, s[12:15], s52 offen offset:2048 sc1
    buffer_load_dwordx4 v[72:75], v36, s[12:15], s52 offen offset:3072 sc1
    buffer_load_dwordx4 v[76:79], v36, s[12:15], s81 offen offset:0 sc1
    buffer_load_dwordx4 v[80:83], v36, s[12:15], s81 offen offset:1024 sc1
    buffer_load_dwordx4 v[84:87], v36, s[12:15], s81 offen offset:2048 sc1
    buffer_load_dwordx4 v[88:91], v36, s[12:15], s81 offen offset:3072 sc1
    buffer_load_dwordx4 v[92:95], v36, s[12:15], s82 offen offset:0 sc1
    buffer_load_dwordx4 v[96:99], v36, s[12:15], s82 offen offset:1024 sc1
    buffer_load_dwordx4 v[100:103], v36, s[12:15], s82 offen offset:2048 sc1
    buffer_load_dwordx4 v[104:107], v36, s[12:15], s82 offen offset:3072 sc1
    buffer_load_dwordx4 v[108:111], v36, s[12:15], s83 offen offset:0 sc1
    buffer_load_dwordx4 v[112:115], v36, s[12:15], s83 offen offset:1024 sc1
    buffer_load_dwordx4 v[116:119], v36, s[12:15], s83 offen offset:2048 sc1
    buffer_load_dwordx4 v[120:123], v36, s[12:15], s83 offen offset:3072 sc1
pq_12:
    s_waitcnt vmcnt(12)
    v_xor_b32 v5, s88, v61
    v_xor_b32 v6, s89, v63
    v_or_b32 v4, v5, v6
    v_xor_b32 v5, s88, v65
    v_xor_b32 v6, s89, v67
    v_or3_b32 v4, v4, v5, v6
    v_xor_b32 v5, s88, v69
    v_xor_b32 v6, s89, v71
    v_or3_b32 v4, v4, v5, v6
    v_xor_b32 v5, s88, v73
    v_xor_b32 v6, s89, v75
    v_or3_b32 v4, v4, v5, v6
    s_waitcnt vmcnt(8)
    v_xor_b32 v5, s88, v77
    v_xor_b32 v6, s89, v79
    v_or3_b32 v4, v4, v5, v6
    v_xor_b32 v5, s88, v81
    v_xor_b32 v6, s89, v83
    v_or3_b32 v4, v4, v5, v6
    v_xor_b32 v5, s88, v85
    v_xor_b32 v6, s89, v87
    v_or3_b32 v4, v4, v5, v6
    v_xor_b32 v5, s88, v89
    v_xor_b32 v6, s89, v91
    v_or3_b32 v4, v4, v5, v6
    s_waitcnt vmcnt(4)
    v_xor_b32 v5, s88, v93
    v_xor_b32 v6, s89, v95
    v_or3_b32 v4, v4, v5, v6
    v_xor_b32 v5, s88, v97
    v_xor_b32 v6, s89, v99
    v_or3_b32 v4, v4, v5, v6
    v_xor_b32 v5, s88, v101
    v_xor_b32 v6, s89, v103
    v_or3_b32 v4, v4, v5, v6
    v_xor_b32 v5, s88, v105
    v_xor_b32 v6, s89, v107
    v_or3_b32 v4, v4, v5, v6
    s_waitcnt vmcnt(0)
    v_xor_b32 v5, s88, v109
    v_xor_b32 v6, s89, v111
    v_or3_b32 v4, v4, v5, v6
    v_xor_b32 v5, s88, v113
    v_xor_b32 v6, s89, v115
    v_or3_b32 v4, v4, v5, v6
    v_xor_b32 v5, s88, v117
    v_xor_b32 v6, s89, v119
    v_or3_b32 v4, v4, v5, v6
    v_xor_b32 v5, s88, v121
    v_xor_b32 v6, s89, v123
    v_or3_b32 v4, v4, v5, v6
    v_cmp_ne_u32 vcc, 0, v4
    s_mov_b64 exec, vcc
    s_cbranch_execz pq_done_13
    s_sub_u32 s56, s56, 1
    s_cbranch_scc1 pq_done_13
    s_sleep 1
    buffer_load_dwordx4 v[60:63], v36, s[12:15], s52 offen offset:0 sc1
    buffer_load_dwordx4 v[64:67], v36, s[12:15], s52 offen offset:1024 sc1
    buffer_load_dwordx4 v[68:71], v36, s[12:15], s52 offen offset:2048 sc1
    buffer_load_dwordx4 v[72:75], v36, s[12:15], s52 offen offset:3072 sc1
    buffer_load_dwordx4 v[76:79], v36, s[12:15], s81 offen offset:0 sc1
    buffer_load_dwordx4 v[80:83], v36, s[12:15], s81 offen offset:1024 sc1
    buffer_load_dwordx4 v[84:87], v36, s[12:15], s81 offen offset:2048 sc1
    buffer_load_dwordx4 v[88:91], v36, s[12:15], s81 offen offset:3072 sc1
    buffer_load_dwordx4 v[92:95], v36, s[12:15], s82 offen offset:0 sc1
    buffer_load_dwordx4 v[96:99], v36, s[12:15], s82 offen offset:1024 sc1
    buffer_load_dwordx4 v[100:103], v36, s[12:15], s82 offen offset:2048 sc1
    buffer_load_dwordx4 v[104:107], v36, s[12:15], s82 offen offset:3072 sc1
    buffer_load_dwordx4 v[108:111], v36, s[12:15], s83 offen offset:0 sc1
    buffer_load_dwordx4 v[112:115], v36, s[12:15], s83 offen offset:1024 sc1
    buffer_load_dwordx4 v[116:119], v36, s[12:15], s83 offen offset:2048 sc1
    buffer_load_dwordx4 v[120:123], v36, s[12:15], s83 offen offset:3072 sc1
    s_branch pq_12
pq_done_13:
    s_mov_b64 exec, -1
    v_add_f32 v60, v60, v76
    v_add_f32 v92, v92, v108
    v_add_f32 v62, v62, v78
    v_add_f32 v94, v94, v110
    v_add_f32 v64, v64, v80
    v_add_f32 v96, v96, v112
    v_add_f32 v66, v66, v82
    v_add_f32 v98, v98, v114
    v_add_f32 v68, v68, v84
    v_add_f32 v100, v100, v116
    v_add_f32 v70, v70, v86
    v_add_f32 v102, v102, v118
    v_add_f32 v72, v72, v88
    v_add_f32 v104, v104, v120
    v_add_f32 v74, v74, v90
    v_add_f32 v106, v106, v122
    v_add_f32 v60, v60, v92
    v_add_f32 v62, v62, v94
    v_add_f32 v64, v64, v96
    v_add_f32 v66, v66, v98
    v_add_f32 v68, v68, v100
    v_add_f32 v70, v70, v102
    v_add_f32 v72, v72, v104
    v_add_f32 v74, v74, v106
    v_cvt_pk_bf16_f32 v4, v60, v62
    v_cvt_pk_bf16_f32 v5, v64, v66
    v_cvt_pk_bf16_f32 v6, v68, v70
    v_cvt_pk_bf16_f32 v7, v72, v74
    ds_write_b32 v37, v4 offset:0
    ds_write_b32 v37, v5 offset:256
    ds_write_b32 v37, v6 offset:512
    ds_write_b32 v37, v7 offset:768
    ds_write_b32 v38, v39 offset:1024
    ds_write_b128 v38, v[220:223] offset:1088
    ds_write_b32 v38, v38 offset:1036
    ds_write_b32 v38, v38 offset:1048
    ds_write_b32 v38, v38 offset:1064
    ds_write_b32 v38, v38 offset:1072
    ds_write_b64 v38, v[220:221] offset:2048
    ds_write_b64 v38, v[220:221] offset:2560
    s_waitcnt lgkmcnt(0)
    s_barrier
    s_lshl_b32 s52, s54, 9
    s_and_b32 s53, s55, 1
    s_lshl_b32 s53, s53, 4
    s_add_u32 s52, s52, s53
    s_and_b32 s53, s55, 6
    s_add_u32 s52, s52, s53
    s_bfe_u32 s53, s55, 0x10003
    s_add_u32 s52, s52, s53
    s_mul_i32 s19, s52, 896
    v_min_u32 v41, 55, v0
    v_lshlrev_b32 v41, 4, v41
    v_and_b32 v37, 31, v0
    v_mul_u32_u24 v37, 4224, v37
    v_lshrrev_b32 v38, 3, v0
    v_mul_u32_u24 v39, 4224, v38
    v_and_b32 v4, 7, v0
    v_lshl_add_u32 v39, v4, 4, v39
    v_lshlrev_b32 v38, 2, v38
    s_mul_i32 s53, s54, 135168
    s_add_u32 s53, s53, 0xa0000
    s_lshl_b32 s52, s55, 7
    s_add_u32 s52, s52, s53
    s_add_u32 s73, s52, 33792
    s_add_u32 s74, s52, 67584
    s_add_u32 s75, s52, 101376
    s_add_u32 s53, s53, 4096
    s_mov_b32 s57, 0x3db8aa3b
    s_lshl_b32 s72, s2, 6
    s_add_u32 s24, s72, 0x300000
    s_add_u32 s25, s72, 0x338000
    s_add_u32 s26, s72, 0x370000
    s_add_u32 s27, s72, 0x3a8000
    v_lshrrev_b32 v40, 2, v0
    v_lshlrev_b32 v40, 14, v40
    v_and_b32 v4, 3, v0
    v_lshl_add_u32 v40, v4, 4, v40
    v_mov_b32 v45, s88
    v_mov_b32 v47, s89
    v_mov_b32 v49, s88
    v_mov_b32 v51, s89
    v_mov_b32 v53, s88
    v_mov_b32 v55, s89
    v_mov_b32 v57, s88
    v_mov_b32 v59, s89
    s_mul_i32 s37, s54, 11
    s_lshr_b32 s37, s37, 5
    s_mul_i32 s37, s37, 3
    s_sub_u32 s37, s54, s37
    s_bfe_u32 s38, s2, 0x20003
    s_lshl_b32 s36, s54, 3
    s_and_b32 s39, s2, 7
    s_add_u32 s36, s36, s39
    s_lshl_b32 s36, s36, 4
    s_cmp_eq_u32 s37, s38
    s_cselect_b32 s36, s36, 0x40000000
    v_mov_b32 v71, 2048
    v_lshlrev_b32 v72, 4, v0
    v_mov_b32 v80, 0
    v_mov_b32 v65, s88
    v_mov_b32 v67, s89
    v_mov_b32 v69, 0x0
    v_mov_b32 v78, 0x32
    v_mov_b32 v79, 0xfffffff1
    s_mov_b32 s28, 0
    s_mov_b32 s38, 0x32323232
    s_mov_b32 s39, 0x14141e28
    s_mov_b32 s29, 48
    s_mov_b32 s32, 0x40000
rd_top_14:
    s_mov_b32 s30, 16384
pl_w_20:
    ds_read_b64 v[60:61], v71
    ds_read_b64 v[62:63], v71 offset:512
    s_waitcnt lgkmcnt(0)
    v_add_u32 v66, v60, v62
    v_add_u32 v64, v61, v63
    v_readfirstlane_b32 s31, v66
    s_cmp_ge_u32 s31, s29
    s_cbranch_scc1 pl_g_21
    s_sub_u32 s30, s30, 1
    s_cbranch_scc1 pl_g_21
    s_sleep 8
    s_branch pl_w_20
pl_g_21:
    s_add_u32 s31, s32, s36
    s_mov_b64 exec, 1
    buffer_store_dwordx4 v[64:67], v80, s[12:15], s31 offen sc1
    s_mov_b64 exec, -1
    s_add_u32 s29, s29, 14
    s_mov_b32 s30, 16384
pl_w_22:
    ds_read_b64 v[60:61], v71
    ds_read_b64 v[62:63], v71 offset:512
    s_waitcnt lgkmcnt(0)
    v_add_u32 v66, v60, v62
    v_add_u32 v64, v61, v63
    v_readfirstlane_b32 s31, v66
    s_cmp_ge_u32 s31, s29
    s_cbranch_scc1 pl_g_23
    s_sub_u32 s30, s30, 1
    s_cbranch_scc1 pl_g_23
    s_sleep 8
    s_branch pl_w_22
pl_g_23:
    s_add_u32 s29, s29, 10
    s_mov_b32 s33, 3
    buffer_load_dwordx4 v[60:63], v72, s[12:15], s32 offen
rd_re_16:
    s_waitcnt vmcnt(0)
    v_xor_b32 v73, s88, v61
    v_xor_b32 v74, s89, v63
    v_or_b32 v73, v73, v74
    v_cmp_eq_u32 vcc, 0, v73
    s_bcnt1_i32_b64 s31, vcc
    s_cmp_ge_u32 s31, 56
    s_cbranch_scc1 rd_go_17
    s_sub_u32 s33, s33, 1
    s_cbranch_scc1 rd_next_15
    s_sleep 16
    buffer_load_dwordx4 v[60:63], v72, s[12:15], s32 offen sc1
    s_branch rd_re_16
rd_go_17:
    v_cvt_f32_i32 v60, v60
    v_cvt_f32_u32 v62, v62
    s_lshl_b32 s31, s31, 1
    v_cvt_f32_u32 v73, s31
    v_cndmask_b32 v60, 0, v60, vcc
    v_cndmask_b32 v62, 0, v62, vcc
    v_rcp_f32 v73, v73
    s_nop 1
    v_add_f32_dpp v60, v60, v60 quad_perm:[1,0,3,2] row_mask:0xf bank_mask:0xf
    v_add_f32_dpp v62, v62, v62 quad_perm:[1,0,3,2] row_mask:0xf bank_mask:0xf
    s_nop 1
    v_add_f32_dpp v60, v60, v60 quad_perm:[2,3,0,1] row_mask:0xf bank_mask:0xf
    v_add_f32_dpp v62, v62, v62 quad_perm:[2,3,0,1] row_mask:0xf bank_mask:0xf
    s_nop 1
    v_add_f32_dpp v60, v60, v60 row_ror:4 row_mask:0xf bank_mask:0xf
    v_add_f32_dpp v62, v62, v62 row_ror:4 row_mask:0xf bank_mask:0xf
    s_nop 1
    v_add_f32_dpp v60, v60, v60 row_ror:8 row_mask:0xf bank_mask:0xf
    v_add_f32_dpp v62, v62, v62 row_ror:8 row_mask:0xf bank_mask:0xf
    v_mov_b32 v81, v60
    v_mov_b32 v82, v62
    s_nop 1
    v_permlane16_swap_b32 v60, v81
    v_permlane16_swap_b32 v62, v82
    v_add_f32 v60, v60, v81
    v_add_f32 v62, v62, v82
    v_mov_b32 v81, v60
    v_mov_b32 v82, v62
    s_nop 1
    v_permlane32_swap_b32 v60, v81
    v_permlane32_swap_b32 v62, v82
    v_add_f32 v60, v60, v81
    v_add_f32 v62, v62, v82
    v_mul_f32 v60, v60, v73
    v_mul_f32 v62, v62, v73
    s_cmp_eq_u32 s28, 0
    s_cbranch_scc1 rd_first_18
    v_fma_f32 v73, v69, v62, v68
    v_sub_f32 v74, v60, v73
    v_sub_f32 v75, v62, v70
    v_rcp_f32 v75, v75
    v_mov_b32 v61, 0x3f333333
    v_fma_f32 v60, v74, v61, v73
    v_mul_f32 v74, 0x3e4ccccd, v74
    v_fma_f32 v69, v74, v75, v69
    v_max_f32 v69, 0xc0400000, v69
    v_min_f32 v69, 0x41100000, v69
rd_first_18:
    v_fma_f32 v68, -v69, v62, v60
    v_mov_b32 v70, v62
    v_mul_f32 v76, 0x43800000, v68
    v_mul_f32 v77, 0x43800000, v69
    v_cvt_i32_f32 v76, v76
    v_cvt_i32_f32 v77, v77
    s_add_u32 s28, s28, 1
    s_sext_i32_i8 s31, s38
    v_mov_b32 v78, s31
    ds_write_b128 v80, v[76:79] offset:1088
rd_next_15:
    s_lshr_b64 s[38:39], s[38:39], 8
    s_add_u32 s32, s32, 1024
    s_cmp_lt_u32 s32, 0x42000
    s_cbranch_scc1 rd_top_14
    s_mov_b64 s[16:17], -1
    v_mov_b32 v64, s88
    v_mov_b32 v65, 0
    s_mov_b32 s56, 65536
za_w_24:
    ds_read_b32 v4, v65 offset:1064
    s_waitcnt lgkmcnt(0)
    v_readfirstlane_b32 s22, v4
    s_cmp_eq_u32 s22, s88
    s_cbranch_scc1 za_g_25
    s_sub_u32 s56, s56, 1
    s_sleep 8
    s_cbranch_scc0 za_w_24
za_g_25:
    ds_read_b128 v[68:71], v36 offset:16384
    ds_read_b128 v[72:75], v36 offset:17408
    ds_read_b32 v66, v65 offset:1044
    ds_read_b32 v4, v65 offset:1068
    s_waitcnt lgkmcnt(0)
    v_readfirstlane_b32 s20, v4
    v_lshlrev_b32 v37, 2, v0
    s_mov_b32 s56, 16384
wo_w_26:
    ds_read_b32 v4, v65 offset:2048
    ds_read_b32 v5, v65 offset:2560
    s_waitcnt lgkmcnt(0)
    v_add_u32 v4, v4, v5
    s_nop 0
    v_readfirstlane_b32 s22, v4
    s_cmp_ge_u32 s22, 252
    s_cbranch_scc1 wo_g_27
    s_sub_u32 s56, s56, 1
    s_cbranch_scc1 wo_g_27
    s_sleep 2
    s_branch wo_w_26
wo_g_27:
    s_bitcmp1_b32 s55, 4
    s_cselect_b32 s22, 5, 0
    s_mul_i32 s22, s22, 28672
    s_add_u32 s22, s22, s19
    s_add_u32 s23, s22, 0
    buffer_load_dwordx4 v[76:79], v41, s[48:51], s23 offen nt
    s_add_u32 s23, s22, 7168
    buffer_load_dwordx4 v[80:83], v41, s[48:51], s23 offen nt
    s_add_u32 s23, s22, 229376
    buffer_load_dwordx4 v[108:111], v41, s[48:51], s23 offen nt
    s_add_u32 s23, s22, 236544
    buffer_load_dwordx4 v[112:115], v41, s[48:51], s23 offen nt
    s_bitcmp1_b32 s55, 4
    s_cselect_b32 s22, 6, 1
    s_mul_i32 s22, s22, 28672
    s_add_u32 s22, s22, s19
    s_add_u32 s23, s22, 0
    buffer_load_dwordx4 v[84:87], v41, s[48:51], s23 offen nt
    s_add_u32 s23, s22, 7168
    buffer_load_dwordx4 v[88:91], v41, s[48:51], s23 offen nt
    s_add_u32 s23, s22, 229376
    buffer_load_dwordx4 v[116:119], v41, s[48:51], s23 offen nt
    s_add_u32 s23, s22, 236544
    buffer_load_dwordx4 v[120:123], v41, s[48:51], s23 offen nt
    s_bitcmp1_b32 s55, 4
    s_cselect_b32 s22, 7, 2
    s_mul_i32 s22, s22, 28672
    s_add_u32 s22, s22, s19
    s_add_u32 s23, s22, 0
    buffer_load_dwordx4 v[92:95], v41, s[48:51], s23 offen nt
    s_add_u32 s23, s22, 7168
    buffer_load_dwordx4 v[96:99], v41, s[48:51], s23 offen nt
    s_add_u32 s23, s22, 229376
    buffer_load_dwordx4 v[124:127], v41, s[48:51], s23 offen nt
    s_add_u32 s23, s22, 236544
    buffer_load_dwordx4 v[128:131], v41, s[48:51], s23 offen nt
    s_bitcmp1_b32 s55, 4
    s_cselect_b32 s22, 3, 4
    s_mul_i32 s22, s22, 28672
    s_add_u32 s22, s22, s19
    s_add_u32 s23, s22, 0
    buffer_load_dwordx4 v[100:103], v41, s[48:51], s23 offen nt
    s_add_u32 s23, s22, 7168
    buffer_load_dwordx4 v[104:107], v41, s[48:51], s23 offen nt
    s_add_u32 s23, s22, 229376
    buffer_load_dwordx4 v[132:135], v41, s[48:51], s23 offen nt
    s_add_u32 s23, s22, 236544
    buffer_load_dwordx4 v[136:139], v41, s[48:51], s23 offen nt
    s_waitcnt vmcnt(0)
    v_perm_b32 v140, v80, v76, s60
    v_perm_b32 v141, v80, v76, s61
    v_perm_b32 v142, v81, v77, s60
    v_perm_b32 v143, v81, v77, s61
    v_perm_b32 v144, v82, v78, s60
    v_perm_b32 v145, v82, v78, s61
    v_perm_b32 v146, v83, v79, s60
    v_perm_b32 v147, v83, v79, s61
    v_perm_b32 v148, v88, v84, s60
    v_perm_b32 v149, v88, v84, s61
    v_perm_b32 v150, v89, v85, s60
    v_perm_b32 v151, v89, v85, s61
    v_perm_b32 v152, v90, v86, s60
    v_perm_b32 v153, v90, v86, s61
    v_perm_b32 v154, v91, v87, s60
    v_perm_b32 v155, v91, v87, s61
    v_perm_b32 v156, v96, v92, s60
    v_perm_b32 v157, v96, v92, s61
    v_perm_b32 v158, v97, v93, s60
    v_perm_b32 v159, v97, v93, s61
    v_perm_b32 v160, v98, v94, s60
    v_perm_b32 v161, v98, v94, s61
    v_perm_b32 v162, v99, v95, s60
    v_perm_b32 v163, v99, v95, s61
    v_perm_b32 v164, v104, v100, s60
    v_perm_b32 v165, v104, v100, s61
    v_perm_b32 v166, v105, v101, s60
    v_perm_b32 v167, v105, v101, s61
    v_perm_b32 v168, v106, v102, s60
    v_perm_b32 v169, v106, v102, s61
    v_perm_b32 v170, v107, v103, s60
    v_perm_b32 v171, v107, v103, s61
    v_perm_b32 v172, v112, v108, s60
    v_perm_b32 v173, v112, v108, s61
    v_perm_b32 v174, v113, v109, s60
    v_perm_b32 v175, v113, v109, s61
    v_perm_b32 v176, v114, v110, s60
    v_perm_b32 v177, v114, v110, s61
    v_perm_b32 v178, v115, v111, s60
    v_perm_b32 v179, v115, v111, s61
    v_perm_b32 v180, v120, v116, s60
    v_perm_b32 v181, v120, v116, s61
    v_perm_b32 v182, v121, v117, s60
    v_perm_b32 v183, v121, v117, s61
    v_perm_b32 v184, v122, v118, s60
    v_perm_b32 v185, v122, v118, s61
    v_perm_b32 v186, v123, v119, s60
    v_perm_b32 v187, v123, v119, s61
    v_perm_b32 v188, v128, v124, s60
    v_perm_b32 v189, v128, v124, s61
    v_perm_b32 v190, v129, v125, s60
    v_perm_b32 v191, v129, v125, s61
    v_perm_b32 v192, v130, v126, s60
    v_perm_b32 v193, v130, v126, s61
    v_perm_b32 v194, v131, v127, s60
    v_perm_b32 v195, v131, v127, s61
    v_perm_b32 v196, v136, v132, s60
    v_perm_b32 v197, v136, v132, s61
    v_perm_b32 v198, v137, v133, s60
    v_perm_b32 v199, v137, v133, s61
    v_perm_b32 v200, v138, v134, s60
    v_perm_b32 v201, v138, v134, s61
    v_perm_b32 v202, v139, v135, s60
    v_perm_b32 v203, v139, v135, s61
    s_mov_b32 s56, 262144
ow_28:
    ds_read_b32 v4, v65 offset:1072
    ds_read_b128 v[204:207], v65 offset:1120
    ds_read_b128 v[208:211], v65 offset:1136
    s_waitcnt lgkmcnt(2)
    v_readfirstlane_b32 s22, v4
    s_cmp_eq_u32 s22, s88
    s_cbranch_scc1 og_29
    s_sub_u32 s56, s56, 1
    s_waitcnt lgkmcnt(0)
    s_cbranch_scc0 ow_28
og_29:
    s_waitcnt lgkmcnt(1)
    v_dot2_f32_bf16 v44, v140, v204, 0
    v_dot2_f32_bf16 v46, v141, v204, 0
    v_dot2_f32_bf16 v48, v142, v204, 0
    v_dot2_f32_bf16 v50, v143, v204, 0
    v_dot2_f32_bf16 v52, v144, v204, 0
    v_dot2_f32_bf16 v54, v145, v204, 0
    v_dot2_f32_bf16 v56, v146, v204, 0
    v_dot2_f32_bf16 v58, v147, v204, 0
    v_dot2_f32_bf16 v44, v148, v205, v44
    v_dot2_f32_bf16 v46, v149, v205, v46
    v_dot2_f32_bf16 v48, v150, v205, v48
    v_dot2_f32_bf16 v50, v151, v205, v50
    v_dot2_f32_bf16 v52, v152, v205, v52
    v_dot2_f32_bf16 v54, v153, v205, v54
    v_dot2_f32_bf16 v56, v154, v205, v56
    v_dot2_f32_bf16 v58, v155, v205, v58
    v_dot2_f32_bf16 v44, v156, v206, v44
    v_dot2_f32_bf16 v46, v157, v206, v46
    v_dot2_f32_bf16 v48, v158, v206, v48
    v_dot2_f32_bf16 v50, v159, v206, v50
    v_dot2_f32_bf16 v52, v160, v206, v52
    v_dot2_f32_bf16 v54, v161, v206, v54
    v_dot2_f32_bf16 v56, v162, v206, v56
    v_dot2_f32_bf16 v58, v163, v206, v58
    v_dot2_f32_bf16 v44, v164, v207, v44
    v_dot2_f32_bf16 v46, v165, v207, v46
    v_dot2_f32_bf16 v48, v166, v207, v48
    v_dot2_f32_bf16 v50, v167, v207, v50
    v_dot2_f32_bf16 v52, v168, v207, v52
    v_dot2_f32_bf16 v54, v169, v207, v54
    v_dot2_f32_bf16 v56, v170, v207, v56
    v_dot2_f32_bf16 v58, v171, v207, v58
    s_waitcnt lgkmcnt(0)
    v_dot2_f32_bf16 v44, v172, v208, v44
    v_dot2_f32_bf16 v46, v173, v208, v46
    v_dot2_f32_bf16 v48, v174, v208, v48
    v_dot2_f32_bf16 v50, v175, v208, v50
    v_dot2_f32_bf16 v52, v176, v208, v52
    v_dot2_f32_bf16 v54, v177, v208, v54
    v_dot2_f32_bf16 v56, v178, v208, v56
    v_dot2_f32_bf16 v58, v179, v208, v58
    v_dot2_f32_bf16 v44, v180, v209, v44
    v_dot2_f32_bf16 v46, v181, v209, v46
    v_dot2_f32_bf16 v48, v182, v209, v48
    v_dot2_f32_bf16 v50, v183, v209, v50
    v_dot2_f32_bf16 v52, v184, v209, v52
    v_dot2_f32_bf16 v54, v185, v209, v54
    v_dot2_f32_bf16 v56, v186, v209, v56
    v_dot2_f32_bf16 v58, v187, v209, v58
    v_dot2_f32_bf16 v44, v188, v210, v44
    v_dot2_f32_bf16 v46, v189, v210, v46
    v_dot2_f32_bf16 v48, v190, v210, v48
    v_dot2_f32_bf16 v50, v191, v210, v50
    v_dot2_f32_bf16 v52, v192, v210, v52
    v_dot2_f32_bf16 v54, v193, v210, v54
    v_dot2_f32_bf16 v56, v194, v210, v56
    v_dot2_f32_bf16 v58, v195, v210, v58
    v_dot2_f32_bf16 v44, v196, v211, v44
    v_dot2_f32_bf16 v46, v197, v211, v46
    v_dot2_f32_bf16 v48, v198, v211, v48
    v_dot2_f32_bf16 v50, v199, v211, v50
    v_dot2_f32_bf16 v52, v200, v211, v52
    v_dot2_f32_bf16 v54, v201, v211, v54
    v_dot2_f32_bf16 v56, v202, v211, v56
    v_dot2_f32_bf16 v58, v203, v211, v58
    s_and_b32 exec_hi, s17, 0x00ffffff
    v_fma_f32 v44, v44, v66, v68
    v_fma_f32 v46, v46, v66, v69
    buffer_store_dwordx4 v[44:47], v40, s[12:15], s24 offen sc1
    v_fma_f32 v48, v48, v66, v70
    v_fma_f32 v50, v50, v66, v71
    buffer_store_dwordx4 v[48:51], v40, s[12:15], s25 offen sc1
    v_fma_f32 v52, v52, v66, v72
    v_fma_f32 v54, v54, v66, v73
    buffer_store_dwordx4 v[52:55], v40, s[12:15], s26 offen sc1
    v_fma_f32 v56, v56, v66, v74
    v_fma_f32 v58, v58, v66, v75
    buffer_store_dwordx4 v[56:59], v40, s[12:15], s27 offen sc1
    s_mov_b64 exec, -1
    ds_write_b32 v65, v64 offset:1048
    s_endpgm
L_auxB:
    s_mov_b32 s64, s38
    s_mov_b32 s65, s39
    s_mov_b32 s66, 0x100
    s_mov_b32 s67, 0x00020000
    v_mov_b32 v25, 0
    s_cmp_lg_u32 s2, 0
    s_cbranch_scc1 notag_30
    s_memrealtime s[62:63]
    s_waitcnt lgkmcnt(0)
    s_or_b32 s62, s62, 1
    v_mov_b32 v21, s62
    s_mov_b64 exec, 1
    buffer_store_dword v21, v25, s[64:67], 0 offen sc1
    s_mov_b64 exec, -1
notag_30:
    s_mov_b32 s4, s16
    s_mov_b32 s5, s17
    s_mov_b32 s6, 0x380
    s_mov_b32 s7, 0x00020000
    s_mov_b32 s48, s32
    s_mov_b32 s49, s33
    s_mov_b32 s50, 0x188000
    s_mov_b32 s51, 0x00020000
    s_mov_b32 s68, s34
    s_mov_b32 s69, s35
    s_mov_b32 s70, 0x380
    s_mov_b32 s71, 0x00020000
    s_mov_b32 s72, s36
    s_mov_b32 s73, s37
    s_mov_b32 s74, 0x380
    s_mov_b32 s75, 0x00020000
    s_lshr_b32 s52, s2, 5
    s_add_u32 s58, s2, s52
    s_and_b32 s58, s58, 31
    s_mul_i32 s57, s52, 14
    s_add_u32 s57, s57, s58
    s_lshr_b32 s59, s57, 1
    s_cmp_ge_u32 s59, 28
    s_cselect_b32 s8, s30, s28
    s_cselect_b32 s9, s31, s29
    s_cselect_b32 s53, 28, 0
    s_cselect_b32 s55, 256, 0
    s_mov_b32 s10, 0x188000
    s_mov_b32 s11, 0x00020000
    s_sub_u32 s59, s59, s53
    v_lshlrev_b32 v24, 4, v0
    s_cmp_ge_u32 s58, 14
    s_cbranch_scc1 fe2_34
    s_and_b32 s54, s57, 1
    s_lshl_b32 s54, s54, 1
    s_lshl_b32 s57, s59, 7
    v_lshrrev_b32 v20, 3, v0
    v_mul_u32_u24 v21, 50176, v20
    v_and_b32 v22, 7, v0
    v_lshl_add_u32 v21, v22, 4, v21
    s_mul_i32 s53, s54, 401408
    s_add_u32 s53, s53, s57
    buffer_load_dwordx4 v[68:71], v21, s[8:11], s53 offen nt
    s_add_u32 s53, s53, 3584
    v_mul_u32_u24 v22, 28, v20
    s_mul_i32 s52, s54, 224
    buffer_load_dwordx4 v[28:31], v22, s[4:7], s52 offen
    buffer_load_dwordx3 v[32:34], v22, s[4:7], s52 offen offset:16
    buffer_load_dwordx4 v[72:75], v21, s[8:11], s53 offen nt
    s_add_u32 s53, s53, 3584
    buffer_load_dwordx4 v[76:79], v21, s[8:11], s53 offen nt
    s_add_u32 s53, s53, 3584
    buffer_load_dwordx4 v[80:83], v21, s[8:11], s53 offen nt
    s_add_u32 s53, s53, 3584
    buffer_load_dwordx4 v[84:87], v21, s[8:11], s53 offen nt
    s_add_u32 s53, s53, 3584
    buffer_load_dwordx4 v[88:91], v21, s[8:11], s53 offen nt
    s_add_u32 s53, s53, 3584
    buffer_load_dwordx4 v[92:95], v21, s[8:11], s53 offen nt
    s_add_u32 s53, s53, 3584
    buffer_load_dwordx4 v[96:99], v21, s[8:11], s53 offen nt
    s_add_u32 s53, s53, 3584
    buffer_load_dwordx4 v[100:103], v21, s[8:11], s53 offen nt
    s_add_u32 s53, s53, 3584
    buffer_load_dwordx4 v[104:107], v21, s[8:11], s53 offen nt
    s_add_u32 s53, s53, 3584
    buffer_load_dwordx4 v[108:111], v21, s[8:11], s53 offen nt
    s_add_u32 s53, s53, 3584
    buffer_load_dwordx4 v[112:115], v21, s[8:11], s53 offen nt
    s_add_u32 s53, s53, 3584
    buffer_load_dwordx4 v[116:119], v21, s[8:11], s53 offen nt
    s_add_u32 s53, s53, 3584
    buffer_load_dwordx4 v[120:123], v21, s[8:11], s53 offen nt
    s_add_u32 s54, s54, 1
    v_lshrrev_b32 v20, 3, v0
    v_mul_u32_u24 v21, 50176, v20
    v_and_b32 v22, 7, v0
    v_lshl_add_u32 v21, v22, 4, v21
    s_mul_i32 s53, s54, 401408
    s_add_u32 s53, s53, s57
    buffer_load_dwordx4 v[132:135], v21, s[8:11], s53 offen nt
    s_add_u32 s53, s53, 3584
    v_mul_u32_u24 v22, 28, v20
    s_mul_i32 s52, s54, 224
    buffer_load_dwordx4 v[36:39], v22, s[4:7], s52 offen
    buffer_load_dwordx3 v[40:42], v22, s[4:7], s52 offen offset:16
    buffer_load_dwordx4 v[136:139], v21, s[8:11], s53 offen nt
    s_add_u32 s53, s53, 3584
    buffer_load_dwordx4 v[140:143], v21, s[8:11], s53 offen nt
    s_add_u32 s53, s53, 3584
    buffer_load_dwordx4 v[144:147], v21, s[8:11], s53 offen nt
    s_add_u32 s53, s53, 3584
    buffer_load_dwordx4 v[148:151], v21, s[8:11], s53 offen nt
    s_add_u32 s53, s53, 3584
    buffer_load_dwordx4 v[152:155], v21, s[8:11], s53 offen nt
    s_add_u32 s53, s53, 3584
    buffer_load_dwordx4 v[156:159], v21, s[8:11], s53 offen nt
    s_add_u32 s53, s53, 3584
    buffer_load_dwordx4 v[160:163], v21, s[8:11], s53 offen nt
    s_add_u32 s53, s53, 3584
    buffer_load_dwordx4 v[164:167], v21, s[8:11], s53 offen nt
    s_add_u32 s53, s53, 3584
    buffer_load_dwordx4 v[168:171], v21, s[8:11], s53 offen nt
    s_add_u32 s53, s53, 3584
    buffer_load_dwordx4 v[172:175], v21, s[8:11], s53 offen nt
    s_add_u32 s53, s53, 3584
    buffer_load_dwordx4 v[176:179], v21, s[8:11], s53 offen nt
    s_add_u32 s53, s53, 3584
    buffer_load_dwordx4 v[180:183], v21, s[8:11], s53 offen nt
    s_add_u32 s53, s53, 3584
    buffer_load_dwordx4 v[184:187], v21, s[8:11], s53 offen nt
    s_branch fed_35
fe2_34:
    s_cmp_ge_u32 s58, 28
    s_cbranch_scc1 fed_35
    s_sub_u32 s57, s57, 14
    v_min_u32 v20, 55, v0
    v_lshlrev_b32 v20, 4, v20
    s_mul_i32 s52, s57, 14336
    buffer_load_dwordx4 v[68:71], v20, s[48:51], s52 offen offset:0 nt
    buffer_load_dwordx4 v[72:75], v20, s[48:51], s52 offen offset:896 nt
    buffer_load_dwordx4 v[76:79], v20, s[48:51], s52 offen offset:1792 nt
    buffer_load_dwordx4 v[80:83], v20, s[48:51], s52 offen offset:2688 nt
    s_add_u32 s52, s52, 3584
    buffer_load_dwordx4 v[84:87], v20, s[48:51], s52 offen offset:0 nt
    buffer_load_dwordx4 v[88:91], v20, s[48:51], s52 offen offset:896 nt
    buffer_load_dwordx4 v[92:95], v20, s[48:51], s52 offen offset:1792 nt
    buffer_load_dwordx4 v[96:99], v20, s[48:51], s52 offen offset:2688 nt
    s_add_u32 s52, s52, 3584
    buffer_load_dwordx4 v[100:103], v20, s[48:51], s52 offen offset:0 nt
    buffer_load_dwordx4 v[104:107], v20, s[48:51], s52 offen offset:896 nt
    buffer_load_dwordx4 v[108:111], v20, s[48:51], s52 offen offset:1792 nt
    buffer_load_dwordx4 v[112:115], v20, s[48:51], s52 offen offset:2688 nt
    s_add_u32 s52, s52, 3584
    buffer_load_dwordx4 v[116:119], v20, s[48:51], s52 offen offset:0 nt
    buffer_load_dwordx4 v[120:123], v20, s[48:51], s52 offen offset:896 nt
    buffer_load_dwordx4 v[124:127], v20, s[48:51], s52 offen offset:1792 nt
    buffer_load_dwordx4 v[128:131], v20, s[48:51], s52 offen offset:2688 nt
fed_35:
    s_barrier
    s_barrier
    ds_read_b32 v21, v25 offset:1024
    buffer_load_dwordx4 v[44:47], v24, s[4:7], 0 offen
    buffer_load_dwordx4 v[48:51], v24, s[68:71], 0 offen
    s_waitcnt lgkmcnt(0)
    v_readfirstlane_b32 s88, v21
    s_mul_i32 s89, s88, 0x9e3779b1
    s_add_u32 s89, s89, 0x7f4a7c15
    v_mov_b32 v60, 0
    v_mov_b32 v61, 0
    v_mov_b32 v62, 0
    v_mov_b32 v63, 0
    v_mov_b32 v64, 0
    v_mov_b32 v65, 0
    v_mov_b32 v66, 0
    v_mov_b32 v67, 0
    s_waitcnt vmcnt(0)
    v_lshlrev_b32 v4, 16, v44
    v_lshlrev_b32 v5, 16, v48
    v_and_b32 v6, 0xffff0000, v44
    v_and_b32 v7, 0xffff0000, v48
    v_mul_f32 v4, v4, v5
    v_mul_f32 v6, v6, v7
    v_cvt_pk_bf16_f32 v4, v4, v6
    v_lshlrev_b32 v5, 16, v4
    v_and_b32 v6, 0xffff0000, v4
    v_add_f32 v23, v5, v6
    v_lshlrev_b32 v4, 16, v45
    v_lshlrev_b32 v5, 16, v49
    v_and_b32 v6, 0xffff0000, v45
    v_and_b32 v7, 0xffff0000, v49
    v_mul_f32 v4, v4, v5
    v_mul_f32 v6, v6, v7
    v_cvt_pk_bf16_f32 v4, v4, v6
    v_lshlrev_b32 v5, 16, v4
    v_and_b32 v6, 0xffff0000, v4
    v_add_f32 v23, v23, v5
    v_add_f32 v23, v23, v6
    v_lshlrev_b32 v4, 16, v46
    v_lshlrev_b32 v5, 16, v50
    v_and_b32 v6, 0xffff0000, v46
    v_and_b32 v7, 0xffff0000, v50
    v_mul_f32 v4, v4, v5
    v_mul_f32 v6, v6, v7
    v_cvt_pk_bf16_f32 v4, v4, v6
    v_lshlrev_b32 v5, 16, v4
    v_and_b32 v6, 0xffff0000, v4
    v_add_f32 v23, v23, v5
    v_add_f32 v23, v23, v6
    v_lshlrev_b32 v4, 16, v47
    v_lshlrev_b32 v5, 16, v51
    v_and_b32 v6, 0xffff0000, v47
    v_and_b32 v7, 0xffff0000, v51
    v_mul_f32 v4, v4, v5
    v_mul_f32 v6, v6, v7
    v_cvt_pk_bf16_f32 v4, v4, v6
    v_lshlrev_b32 v5, 16, v4
    v_and_b32 v6, 0xffff0000, v4
    v_add_f32 v23, v23, v5
    v_add_f32 v23, v23, v6
    s_nop 1
    v_add_f32_dpp v23, v23, v23 quad_perm:[1,0,3,2] row_mask:0xf bank_mask:0xf
    s_nop 1
    v_add_f32_dpp v23, v23, v23 quad_perm:[2,3,0,1] row_mask:0xf bank_mask:0xf
    s_nop 1
    v_add_f32_dpp v23, v23, v23 row_ror:4 row_mask:0xf bank_mask:0xf
    s_nop 1
    v_add_f32_dpp v23, v23, v23 row_ror:8 row_mask:0xf bank_mask:0xf
    v_mov_b32 v4, v23
    s_nop 1
    v_permlane16_swap_b32 v23, v4
    s_nop 0
    v_add_f32 v23, v23, v4
    v_mov_b32 v4, v23
    s_nop 1
    v_permlane32_swap_b32 v23, v4
    s_nop 0
    v_add_f32 v23, v23, v4
    v_cvt_pk_bf16_f32 v4, v23, v23
    v_lshlrev_b32 v23, 16, v4
    v_mul_f32 v23, 0xbfb8aa3b, v23
    v_exp_f32 v23, v23
    s_nop 0
    v_add_f32 v23, 1.0, v23
    v_rcp_f32 v23, v23
    s_nop 0
    v_cvt_pk_bf16_f32 v4, v23, v23
    v_lshlrev_b32 v23, 16, v4
    v_sub_f32 v5, 1.0, v23
    v_cvt_pk_bf16_f32 v4, v5, v5
    v_lshlrev_b32 v5, 16, v4
    ds_write_b32 v25, v23 offset:1044
    v_readfirstlane_b32 s63, v5
    s_cmp_ge_u32 s58, 14
    s_cbranch_scc1 ffn2_31
    v_bfe_u32 v20, v0, 1, 2
    v_lshlrev_b32 v20, 9, v20
    v_and_b32 v21, 1, v0
    v_lshl_or_b32 v20, v21, 6, v20
    v_bfe_u32 v21, v0, 3, 2
    v_lshl_or_b32 v20, v21, 4, v20
    s_lshl_b32 s52, s59, 11
    s_add_u32 s52, s52, s55
    s_lshl_b32 s54, s54, 6
    s_and_b32 s54, s54, 128
    s_add_u32 s52, s52, s54
    s_add_u32 s52, s52, 0x400000
    v_perm_b32 v52, v72, v68, s60
    v_perm_b32 v53, v72, v68, s61
    v_perm_b32 v54, v73, v69, s60
    v_perm_b32 v55, v73, v69, s61
    v_perm_b32 v56, v74, v70, s60
    v_perm_b32 v57, v74, v70, s61
    v_perm_b32 v58, v75, v71, s60
    v_perm_b32 v59, v75, v71, s61
    v_dot2_f32_bf16 v44, v52, v28, 0
    v_dot2_f32_bf16 v45, v53, v28, 0
    v_dot2_f32_bf16 v46, v54, v28, 0
    v_dot2_f32_bf16 v47, v55, v28, 0
    v_dot2_f32_bf16 v48, v56, v28, 0
    v_dot2_f32_bf16 v49, v57, v28, 0
    v_dot2_f32_bf16 v50, v58, v28, 0
    v_dot2_f32_bf16 v51, v59, v28, 0
    v_perm_b32 v52, v80, v76, s60
    v_perm_b32 v53, v80, v76, s61
    v_perm_b32 v54, v81, v77, s60
    v_perm_b32 v55, v81, v77, s61
    v_perm_b32 v56, v82, v78, s60
    v_perm_b32 v57, v82, v78, s61
    v_perm_b32 v58, v83, v79, s60
    v_perm_b32 v59, v83, v79, s61
    v_dot2_f32_bf16 v44, v52, v29, v44
    v_dot2_f32_bf16 v45, v53, v29, v45
    v_dot2_f32_bf16 v46, v54, v29, v46
    v_dot2_f32_bf16 v47, v55, v29, v47
    v_dot2_f32_bf16 v48, v56, v29, v48
    v_dot2_f32_bf16 v49, v57, v29, v49
    v_dot2_f32_bf16 v50, v58, v29, v50
    v_dot2_f32_bf16 v51, v59, v29, v51
    v_perm_b32 v52, v88, v84, s60
    v_perm_b32 v53, v88, v84, s61
    v_perm_b32 v54, v89, v85, s60
    v_perm_b32 v55, v89, v85, s61
    v_perm_b32 v56, v90, v86, s60
    v_perm_b32 v57, v90, v86, s61
    v_perm_b32 v58, v91, v87, s60
    v_perm_b32 v59, v91, v87, s61
    v_dot2_f32_bf16 v44, v52, v30, v44
    v_dot2_f32_bf16 v45, v53, v30, v45
    v_dot2_f32_bf16 v46, v54, v30, v46
    v_dot2_f32_bf16 v47, v55, v30, v47
    v_dot2_f32_bf16 v48, v56, v30, v48
    v_dot2_f32_bf16 v49, v57, v30, v49
    v_dot2_f32_bf16 v50, v58, v30, v50
    v_dot2_f32_bf16 v51, v59, v30, v51
    v_perm_b32 v52, v96, v92, s60
    v_perm_b32 v53, v96, v92, s61
    v_perm_b32 v54, v97, v93, s60
    v_perm_b32 v55, v97, v93, s61
    v_perm_b32 v56, v98, v94, s60
    v_perm_b32 v57, v98, v94, s61
    v_perm_b32 v58, v99, v95, s60
    v_perm_b32 v59, v99, v95, s61
    v_dot2_f32_bf16 v44, v52, v31, v44
    v_dot2_f32_bf16 v45, v53, v31, v45
    v_dot2_f32_bf16 v46, v54, v31, v46
    v_dot2_f32_bf16 v47, v55, v31, v47
    v_dot2_f32_bf16 v48, v56, v31, v48
    v_dot2_f32_bf16 v49, v57, v31, v49
    v_dot2_f32_bf16 v50, v58, v31, v50
    v_dot2_f32_bf16 v51, v59, v31, v51
    v_perm_b32 v52, v104, v100, s60
    v_perm_b32 v53, v104, v100, s61
    v_perm_b32 v54, v105, v101, s60
    v_perm_b32 v55, v105, v101, s61
    v_perm_b32 v56, v106, v102, s60
    v_perm_b32 v57, v106, v102, s61
    v_perm_b32 v58, v107, v103, s60
    v_perm_b32 v59, v107, v103, s61
    v_dot2_f32_bf16 v44, v52, v32, v44
    v_dot2_f32_bf16 v45, v53, v32, v45
    v_dot2_f32_bf16 v46, v54, v32, v46
    v_dot2_f32_bf16 v47, v55, v32, v47
    v_dot2_f32_bf16 v48, v56, v32, v48
    v_dot2_f32_bf16 v49, v57, v32, v49
    v_dot2_f32_bf16 v50, v58, v32, v50
    v_dot2_f32_bf16 v51, v59, v32, v51
    v_perm_b32 v52, v112, v108, s60
    v_perm_b32 v53, v112, v108, s61
    v_perm_b32 v54, v113, v109, s60
    v_perm_b32 v55, v113, v109, s61
    v_perm_b32 v56, v114, v110, s60
    v_perm_b32 v57, v114, v110, s61
    v_perm_b32 v58, v115, v111, s60
    v_perm_b32 v59, v115, v111, s61
    v_dot2_f32_bf16 v44, v52, v33, v44
    v_dot2_f32_bf16 v45, v53, v33, v45
    v_dot2_f32_bf16 v46, v54, v33, v46
    v_dot2_f32_bf16 v47, v55, v33, v47
    v_dot2_f32_bf16 v48, v56, v33, v48
    v_dot2_f32_bf16 v49, v57, v33, v49
    v_dot2_f32_bf16 v50, v58, v33, v50
    v_dot2_f32_bf16 v51, v59, v33, v51
    v_perm_b32 v52, v120, v116, s60
    v_perm_b32 v53, v120, v116, s61
    v_perm_b32 v54, v121, v117, s60
    v_perm_b32 v55, v121, v117, s61
    v_perm_b32 v56, v122, v118, s60
    v_perm_b32 v57, v122, v118, s61
    v_perm_b32 v58, v123, v119, s60
    v_perm_b32 v59, v123, v119, s61
    v_dot2_f32_bf16 v44, v52, v34, v44
    v_dot2_f32_bf16 v45, v53, v34, v45
    v_dot2_f32_bf16 v46, v54, v34, v46
    v_dot2_f32_bf16 v47, v55, v34, v47
    v_dot2_f32_bf16 v48, v56, v34, v48
    v_dot2_f32_bf16 v49, v57, v34, v49
    v_dot2_f32_bf16 v50, v58, v34, v50
    v_dot2_f32_bf16 v51, v59, v34, v51
    s_nop 2
    v_perm_b32 v52, v136, v132, s60
    v_perm_b32 v53, v136, v132, s61
    v_perm_b32 v54, v137, v133, s60
    v_perm_b32 v55, v137, v133, s61
    v_perm_b32 v56, v138, v134, s60
    v_perm_b32 v57, v138, v134, s61
    v_perm_b32 v58, v139, v135, s60
    v_perm_b32 v59, v139, v135, s61
    v_dot2_f32_bf16 v44, v52, v36, v44
    v_dot2_f32_bf16 v45, v53, v36, v45
    v_dot2_f32_bf16 v46, v54, v36, v46
    v_dot2_f32_bf16 v47, v55, v36, v47
    v_dot2_f32_bf16 v48, v56, v36, v48
    v_dot2_f32_bf16 v49, v57, v36, v49
    v_dot2_f32_bf16 v50, v58, v36, v50
    v_dot2_f32_bf16 v51, v59, v36, v51
    v_perm_b32 v52, v144, v140, s60
    v_perm_b32 v53, v144, v140, s61
    v_perm_b32 v54, v145, v141, s60
    v_perm_b32 v55, v145, v141, s61
    v_perm_b32 v56, v146, v142, s60
    v_perm_b32 v57, v146, v142, s61
    v_perm_b32 v58, v147, v143, s60
    v_perm_b32 v59, v147, v143, s61
    v_dot2_f32_bf16 v44, v52, v37, v44
    v_dot2_f32_bf16 v45, v53, v37, v45
    v_dot2_f32_bf16 v46, v54, v37, v46
    v_dot2_f32_bf16 v47, v55, v37, v47
    v_dot2_f32_bf16 v48, v56, v37, v48
    v_dot2_f32_bf16 v49, v57, v37, v49
    v_dot2_f32_bf16 v50, v58, v37, v50
    v_dot2_f32_bf16 v51, v59, v37, v51
    v_perm_b32 v52, v152, v148, s60
    v_perm_b32 v53, v152, v148, s61
    v_perm_b32 v54, v153, v149, s60
    v_perm_b32 v55, v153, v149, s61
    v_perm_b32 v56, v154, v150, s60
    v_perm_b32 v57, v154, v150, s61
    v_perm_b32 v58, v155, v151, s60
    v_perm_b32 v59, v155, v151, s61
    v_dot2_f32_bf16 v44, v52, v38, v44
    v_dot2_f32_bf16 v45, v53, v38, v45
    v_dot2_f32_bf16 v46, v54, v38, v46
    v_dot2_f32_bf16 v47, v55, v38, v47
    v_dot2_f32_bf16 v48, v56, v38, v48
    v_dot2_f32_bf16 v49, v57, v38, v49
    v_dot2_f32_bf16 v50, v58, v38, v50
    v_dot2_f32_bf16 v51, v59, v38, v51
    v_perm_b32 v52, v160, v156, s60
    v_perm_b32 v53, v160, v156, s61
    v_perm_b32 v54, v161, v157, s60
    v_perm_b32 v55, v161, v157, s61
    v_perm_b32 v56, v162, v158, s60
    v_perm_b32 v57, v162, v158, s61
    v_perm_b32 v58, v163, v159, s60
    v_perm_b32 v59, v163, v159, s61
    v_dot2_f32_bf16 v44, v52, v39, v44
    v_dot2_f32_bf16 v45, v53, v39, v45
    v_dot2_f32_bf16 v46, v54, v39, v46
    v_dot2_f32_bf16 v47, v55, v39, v47
    v_dot2_f32_bf16 v48, v56, v39, v48
    v_dot2_f32_bf16 v49, v57, v39, v49
    v_dot2_f32_bf16 v50, v58, v39, v50
    v_dot2_f32_bf16 v51, v59, v39, v51
    v_perm_b32 v52, v168, v164, s60
    v_perm_b32 v53, v168, v164, s61
    v_perm_b32 v54, v169, v165, s60
    v_perm_b32 v55, v169, v165, s61
    v_perm_b32 v56, v170, v166, s60
    v_perm_b32 v57, v170, v166, s61
    v_perm_b32 v58, v171, v167, s60
    v_perm_b32 v59, v171, v167, s61
    v_dot2_f32_bf16 v44, v52, v40, v44
    v_dot2_f32_bf16 v45, v53, v40, v45
    v_dot2_f32_bf16 v46, v54, v40, v46
    v_dot2_f32_bf16 v47, v55, v40, v47
    v_dot2_f32_bf16 v48, v56, v40, v48
    v_dot2_f32_bf16 v49, v57, v40, v49
    v_dot2_f32_bf16 v50, v58, v40, v50
    v_dot2_f32_bf16 v51, v59, v40, v51
    v_perm_b32 v52, v176, v172, s60
    v_perm_b32 v53, v176, v172, s61
    v_perm_b32 v54, v177, v173, s60
    v_perm_b32 v55, v177, v173, s61
    v_perm_b32 v56, v178, v174, s60
    v_perm_b32 v57, v178, v174, s61
    v_perm_b32 v58, v179, v175, s60
    v_perm_b32 v59, v179, v175, s61
    v_dot2_f32_bf16 v44, v52, v41, v44
    v_dot2_f32_bf16 v45, v53, v41, v45
    v_dot2_f32_bf16 v46, v54, v41, v46
    v_dot2_f32_bf16 v47, v55, v41, v47
    v_dot2_f32_bf16 v48, v56, v41, v48
    v_dot2_f32_bf16 v49, v57, v41, v49
    v_dot2_f32_bf16 v50, v58, v41, v50
    v_dot2_f32_bf16 v51, v59, v41, v51
    v_perm_b32 v52, v184, v180, s60
    v_perm_b32 v53, v184, v180, s61
    v_perm_b32 v54, v185, v181, s60
    v_perm_b32 v55, v185, v181, s61
    v_perm_b32 v56, v186, v182, s60
    v_perm_b32 v57, v186, v182, s61
    v_perm_b32 v58, v187, v183, s60
    v_perm_b32 v59, v187, v183, s61
    v_dot2_f32_bf16 v44, v52, v42, v44
    v_dot2_f32_bf16 v45, v53, v42, v45
    v_dot2_f32_bf16 v46, v54, v42, v46
    v_dot2_f32_bf16 v47, v55, v42, v47
    v_dot2_f32_bf16 v48, v56, v42, v48
    v_dot2_f32_bf16 v49, v57, v42, v49
    v_dot2_f32_bf16 v50, v58, v42, v50
    v_dot2_f32_bf16 v51, v59, v42, v51
    s_nop 2
    v_add_f32_dpp v44, v44, v44 row_ror:8 row_mask:0xf bank_mask:0xf
    v_add_f32_dpp v45, v45, v45 row_ror:8 row_mask:0xf bank_mask:0xf
    v_add_f32_dpp v46, v46, v46 row_ror:8 row_mask:0xf bank_mask:0xf
    v_add_f32_dpp v47, v47, v47 row_ror:8 row_mask:0xf bank_mask:0xf
    v_add_f32_dpp v48, v48, v48 row_ror:8 row_mask:0xf bank_mask:0xf
    v_add_f32_dpp v49, v49, v49 row_ror:8 row_mask:0xf bank_mask:0xf
    v_add_f32_dpp v50, v50, v50 row_ror:8 row_mask:0xf bank_mask:0xf
    v_add_f32_dpp v51, v51, v51 row_ror:8 row_mask:0xf bank_mask:0xf
    v_mov_b32 v52, v44
    v_mov_b32 v53, v45
    v_mov_b32 v54, v46
    v_mov_b32 v55, v47
    v_mov_b32 v56, v48
    v_mov_b32 v57, v49
    v_mov_b32 v58, v50
    v_mov_b32 v59, v51
    s_nop 1
    v_permlane16_swap_b32 v44, v52
    v_permlane16_swap_b32 v45, v53
    v_permlane16_swap_b32 v46, v54
    v_permlane16_swap_b32 v47, v55
    v_permlane16_swap_b32 v48, v56
    v_permlane16_swap_b32 v49, v57
    v_permlane16_swap_b32 v50, v58
    v_permlane16_swap_b32 v51, v59
    v_add_f32 v44, v44, v52
    v_add_f32 v45, v45, v53
    v_add_f32 v46, v46, v54
    v_add_f32 v47, v47, v55
    v_add_f32 v48, v48, v56
    v_add_f32 v49, v49, v57
    v_add_f32 v50, v50, v58
    v_add_f32 v51, v51, v59
    v_mov_b32 v52, v44
    v_mov_b32 v53, v45
    v_mov_b32 v54, v46
    v_mov_b32 v55, v47
    v_mov_b32 v56, v48
    v_mov_b32 v57, v49
    v_mov_b32 v58, v50
    v_mov_b32 v59, v51
    s_nop 1
    v_permlane32_swap_b32 v44, v52
    v_permlane32_swap_b32 v45, v53
    v_permlane32_swap_b32 v46, v54
    v_permlane32_swap_b32 v47, v55
    v_permlane32_swap_b32 v48, v56
    v_permlane32_swap_b32 v49, v57
    v_permlane32_swap_b32 v50, v58
    v_permlane32_swap_b32 v51, v59
    v_add_f32 v44, v44, v52
    v_add_f32 v45, v45, v53
    v_add_f32 v46, v46, v54
    v_add_f32 v47, v47, v55
    v_add_f32 v48, v48, v56
    v_add_f32 v49, v49, v57
    v_add_f32 v50, v50, v58
    v_add_f32 v51, v51, v59
    s_mov_b32 vcc_lo, 0xff00ff00
    s_mov_b32 vcc_hi, 0xff00ff00
    v_cndmask_b32 v52, v44, v46, vcc
    v_cndmask_b32 v53, v45, v47, vcc
    v_cndmask_b32 v54, v48, v50, vcc
    v_cndmask_b32 v55, v49, v51, vcc
    s_mov_b32 vcc_lo, 0xffff0000
    s_mov_b32 vcc_hi, 0xffff0000
    v_cndmask_b32 v4, v52, v54, vcc
    v_cndmask_b32 v6, v53, v55, vcc
    v_mov_b32 v5, s88
    v_mov_b32 v7, s89
    s_mov_b32 exec_hi, 0
    buffer_store_dwordx4 v[4:7], v20, s[12:15], s52 offen sc1
    s_mov_b32 exec_hi, -1
    s_branch ffnd_32
ffn2_31:
    s_cmp_ge_u32 s58, 28
    s_cbranch_scc1 ffnd_32
    s_waitcnt vmcnt(0)
    v_perm_b32 v132, v72, v68, s60
    v_perm_b32 v133, v72, v68, s61
    v_perm_b32 v134, v73, v69, s60
    v_perm_b32 v135, v73, v69, s61
    v_perm_b32 v136, v74, v70, s60
    v_perm_b32 v137, v74, v70, s61
    v_perm_b32 v138, v75, v71, s60
    v_perm_b32 v139, v75, v71, s61
    v_perm_b32 v140, v80, v76, s60
    v_perm_b32 v141, v80, v76, s61
    v_perm_b32 v142, v81, v77, s60
    v_perm_b32 v143, v81, v77, s61
    v_perm_b32 v144, v82, v78, s60
    v_perm_b32 v145, v82, v78, s61
    v_perm_b32 v146, v83, v79, s60
    v_perm_b32 v147, v83, v79, s61
    v_perm_b32 v148, v88, v84, s60
    v_perm_b32 v149, v88, v84, s61
    v_perm_b32 v150, v89, v85, s60
    v_perm_b32 v151, v89, v85, s61
    v_perm_b32 v152, v90, v86, s60
    v_perm_b32 v153, v90, v86, s61
    v_perm_b32 v154, v91, v87, s60
    v_perm_b32 v155, v91, v87, s61
    v_perm_b32 v156, v96, v92, s60
    v_perm_b32 v157, v96, v92, s61
    v_perm_b32 v158, v97, v93, s60
    v_perm_b32 v159, v97, v93, s61
    v_perm_b32 v160, v98, v94, s60
    v_perm_b32 v161, v98, v94, s61
    v_perm_b32 v162, v99, v95, s60
    v_perm_b32 v163, v99, v95, s61
    v_perm_b32 v164, v104, v100, s60
    v_perm_b32 v165, v104, v100, s61
    v_perm_b32 v166, v105, v101, s60
    v_perm_b32 v167, v105, v101, s61
    v_perm_b32 v168, v106, v102, s60
    v_perm_b32 v169, v106, v102, s61
    v_perm_b32 v170, v107, v103, s60
    v_perm_b32 v171, v107, v103, s61
    v_perm_b32 v172, v112, v108, s60
    v_perm_b32 v173, v112, v108, s61
    v_perm_b32 v174, v113, v109, s60
    v_perm_b32 v175, v113, v109, s61
    v_perm_b32 v176, v114, v110, s60
    v_perm_b32 v177, v114, v110, s61
    v_perm_b32 v178, v115, v111, s60
    v_perm_b32 v179, v115, v111, s61
    v_perm_b32 v180, v120, v116, s60
    v_perm_b32 v181, v120, v116, s61
    v_perm_b32 v182, v121, v117, s60
    v_perm_b32 v183, v121, v117, s61
    v_perm_b32 v184, v122, v118, s60
    v_perm_b32 v185, v122, v118, s61
    v_perm_b32 v186, v123, v119, s60
    v_perm_b32 v187, v123, v119, s61
    v_perm_b32 v188, v128, v124, s60
    v_perm_b32 v189, v128, v124, s61
    v_perm_b32 v190, v129, v125, s60
    v_perm_b32 v191, v129, v125, s61
    v_perm_b32 v192, v130, v126, s60
    v_perm_b32 v193, v130, v126, s61
    v_perm_b32 v194, v131, v127, s60
    v_perm_b32 v195, v131, v127, s61
    s_mov_b32 s56, 16384
fl_w_36:
    ds_read_b32 v21, v25 offset:2048
    s_waitcnt lgkmcnt(0)
    v_readfirstlane_b32 s52, v21
    s_cmp_ge_u32 s52, 28
    s_cbranch_scc1 fl_g_37
    s_sub_u32 s56, s56, 1
    s_cbranch_scc1 fl_g_37
    s_sleep 64
    s_branch fl_w_36
fl_g_37:
    s_lshl_b32 s52, s57, 9
    s_add_u32 s52, s52, 0x400000
    v_and_b32 v21, 0x1f0, v24
    s_mov_b32 s56, 16384
    buffer_load_dwordx4 v[28:31], v21, s[12:15], s52 offen sc1
pb_38:
    s_waitcnt vmcnt(0)
    v_xor_b32 v5, s88, v29
    v_xor_b32 v6, s89, v31
    v_or_b32 v4, v5, v6
    v_cmp_ne_u32 vcc, 0, v4
    s_mov_b64 exec, vcc
    s_cbranch_execz pb_done_39
    s_sub_u32 s56, s56, 1
    s_cbranch_scc1 pb_done_39
    s_sleep 32
    buffer_load_dwordx4 v[28:31], v21, s[12:15], s52 offen sc1
    s_branch pb_38
pb_done_39:
    s_mov_b64 exec, -1
    s_nop 1
    v_add_f32_dpp v28, v28, v28 row_ror:8 row_mask:0xf bank_mask:0xf
    v_add_f32_dpp v30, v30, v30 row_ror:8 row_mask:0xf bank_mask:0xf
    v_cvt_pk_bf16_f32 v4, v28, v28
    v_lshlrev_b32 v44, 16, v4
    v_cvt_pk_bf16_f32 v5, v30, v30
    v_lshlrev_b32 v45, 16, v5
    v_mov_b32 v46, v44
    v_mov_b32 v47, v45
    s_mov_b32 s52, 0x3d372713
    s_mov_b32 s53, 0xc0135761
    v_permlane16_swap_b32 v44, v46
    v_permlane16_swap_b32 v45, v47
    v_mul_f32 v52, v44, v44
    v_mul_f32 v52, v52, v44
    v_fma_f32 v52, v52, s52, v44
    v_mul_f32 v52, s53, v52
    v_mul_f32 v53, v45, v45
    v_mul_f32 v53, v53, v45
    v_fma_f32 v53, v53, s52, v45
    v_mul_f32 v53, s53, v53
    v_exp_f32 v52, v52
    v_exp_f32 v53, v53
    s_nop 0
    v_add_f32 v52, 1.0, v52
    v_add_f32 v53, 1.0, v53
    v_rcp_f32 v52, v52
    v_rcp_f32 v53, v53
    s_nop 0
    v_mul_f32 v44, v44, v52
    v_mul_f32 v45, v45, v53
    v_cvt_pk_bf16_f32 v52, v44, v44
    v_lshlrev_b32 v44, 16, v52
    v_cvt_pk_bf16_f32 v53, v45, v45
    v_lshlrev_b32 v45, 16, v53
    v_mul_f32 v44, v44, v46
    v_mul_f32 v45, v45, v47
    v_cvt_pk_bf16_f32 v4, v44, v45
    s_nop 0
    v_readlane_b32 s16, v4, 0
    v_readlane_b32 s17, v4, 1
    v_readlane_b32 s18, v4, 2
    v_readlane_b32 s19, v4, 3
    v_readlane_b32 s20, v4, 4
    v_readlane_b32 s21, v4, 5
    v_readlane_b32 s22, v4, 6
    v_readlane_b32 s23, v4, 7
    s_nop 1
    v_dot2_f32_bf16 v60, v132, s16, v60
    v_dot2_f32_bf16 v61, v133, s16, v61
    v_dot2_f32_bf16 v62, v134, s16, v62
    v_dot2_f32_bf16 v63, v135, s16, v63
    v_dot2_f32_bf16 v64, v136, s16, v64
    v_dot2_f32_bf16 v65, v137, s16, v65
    v_dot2_f32_bf16 v66, v138, s16, v66
    v_dot2_f32_bf16 v67, v139, s16, v67
    v_dot2_f32_bf16 v60, v140, s17, v60
    v_dot2_f32_bf16 v61, v141, s17, v61
    v_dot2_f32_bf16 v62, v142, s17, v62
    v_dot2_f32_bf16 v63, v143, s17, v63
    v_dot2_f32_bf16 v64, v144, s17, v64
    v_dot2_f32_bf16 v65, v145, s17, v65
    v_dot2_f32_bf16 v66, v146, s17, v66
    v_dot2_f32_bf16 v67, v147, s17, v67
    v_dot2_f32_bf16 v60, v148, s18, v60
    v_dot2_f32_bf16 v61, v149, s18, v61
    v_dot2_f32_bf16 v62, v150, s18, v62
    v_dot2_f32_bf16 v63, v151, s18, v63
    v_dot2_f32_bf16 v64, v152, s18, v64
    v_dot2_f32_bf16 v65, v153, s18, v65
    v_dot2_f32_bf16 v66, v154, s18, v66
    v_dot2_f32_bf16 v67, v155, s18, v67
    v_dot2_f32_bf16 v60, v156, s19, v60
    v_dot2_f32_bf16 v61, v157, s19, v61
    v_dot2_f32_bf16 v62, v158, s19, v62
    v_dot2_f32_bf16 v63, v159, s19, v63
    v_dot2_f32_bf16 v64, v160, s19, v64
    v_dot2_f32_bf16 v65, v161, s19, v65
    v_dot2_f32_bf16 v66, v162, s19, v66
    v_dot2_f32_bf16 v67, v163, s19, v67
    v_dot2_f32_bf16 v60, v164, s20, v60
    v_dot2_f32_bf16 v61, v165, s20, v61
    v_dot2_f32_bf16 v62, v166, s20, v62
    v_dot2_f32_bf16 v63, v167, s20, v63
    v_dot2_f32_bf16 v64, v168, s20, v64
    v_dot2_f32_bf16 v65, v169, s20, v65
    v_dot2_f32_bf16 v66, v170, s20, v66
    v_dot2_f32_bf16 v67, v171, s20, v67
    v_dot2_f32_bf16 v60, v172, s21, v60
    v_dot2_f32_bf16 v61, v173, s21, v61
    v_dot2_f32_bf16 v62, v174, s21, v62
    v_dot2_f32_bf16 v63, v175, s21, v63
    v_dot2_f32_bf16 v64, v176, s21, v64
    v_dot2_f32_bf16 v65, v177, s21, v65
    v_dot2_f32_bf16 v66, v178, s21, v66
    v_dot2_f32_bf16 v67, v179, s21, v67
    v_dot2_f32_bf16 v60, v180, s22, v60
    v_dot2_f32_bf16 v61, v181, s22, v61
    v_dot2_f32_bf16 v62, v182, s22, v62
    v_dot2_f32_bf16 v63, v183, s22, v63
    v_dot2_f32_bf16 v64, v184, s22, v64
    v_dot2_f32_bf16 v65, v185, s22, v65
    v_dot2_f32_bf16 v66, v186, s22, v66
    v_dot2_f32_bf16 v67, v187, s22, v67
    v_dot2_f32_bf16 v60, v188, s23, v60
    v_dot2_f32_bf16 v61, v189, s23, v61
    v_dot2_f32_bf16 v62, v190, s23, v62
    v_dot2_f32_bf16 v63, v191, s23, v63
    v_dot2_f32_bf16 v64, v192, s23, v64
    v_dot2_f32_bf16 v65, v193, s23, v65
    v_dot2_f32_bf16 v66, v194, s23, v66
    v_dot2_f32_bf16 v67, v195, s23, v67
    s_nop 2
    v_mul_f32 v60, s63, v60
    v_mul_f32 v61, s63, v61
    v_mul_f32 v62, s63, v62
    v_mul_f32 v63, s63, v63
    v_mul_f32 v64, s63, v64
    v_mul_f32 v65, s63, v65
    v_mul_f32 v66, s63, v66
    v_mul_f32 v67, s63, v67
ffnd_32:
    ds_write_b128 v24, v[60:63] offset:16384
    ds_write_b128 v24, v[64:67] offset:17408
    s_mov_b32 s34, 0x3db8aa3b
    s_lshl_b32 s35, s2, 5
    s_add_u32 s35, s35, 0x60000
    s_and_b32 s36, s35, 0xfffffc00
    v_lshlrev_b32 v20, 3, v0
    v_mov_b32 v22, s88
    s_mov_b32 s56, 16384
mlw_w_40:
    ds_read_b32 v4, v25 offset:2048
    ds_read_b32 v5, v25 offset:2560
    s_waitcnt lgkmcnt(0)
    v_min_u32 v4, v4, v5
    s_nop 0
    v_readfirstlane_b32 s52, v4
    s_cmp_ge_u32 s52, 63
    s_cbranch_scc1 mlw_g_41
    s_sub_u32 s56, s56, 1
    s_cbranch_scc1 mlw_g_41
    s_sleep 32
    s_branch mlw_w_40
mlw_g_41:
    ds_read_b128 v[132:135], v24 offset:8192
    ds_read_b128 v[136:139], v24 offset:9216
    ds_read_b128 v[140:143], v24 offset:10240
    ds_read_b128 v[144:147], v24 offset:11264
    ds_read_b128 v[148:151], v24 offset:12288
    ds_read_b128 v[152:155], v24 offset:13312
    ds_read_b128 v[156:159], v24 offset:14336
    ds_read_b128 v[160:163], v24 offset:15360
    s_waitcnt lgkmcnt(7)
    v_lshlrev_b32 v68, 16, v132
    v_and_b32 v69, 0xffff0000, v132
    v_lshlrev_b32 v70, 16, v133
    v_and_b32 v71, 0xffff0000, v133
    v_lshlrev_b32 v72, 16, v134
    v_and_b32 v73, 0xffff0000, v134
    v_lshlrev_b32 v74, 16, v135
    v_and_b32 v75, 0xffff0000, v135
    s_waitcnt lgkmcnt(6)
    v_lshlrev_b32 v76, 16, v136
    v_and_b32 v77, 0xffff0000, v136
    v_lshlrev_b32 v78, 16, v137
    v_and_b32 v79, 0xffff0000, v137
    v_lshlrev_b32 v80, 16, v138
    v_and_b32 v81, 0xffff0000, v138
    v_lshlrev_b32 v82, 16, v139
    v_and_b32 v83, 0xffff0000, v139
    s_waitcnt lgkmcnt(5)
    v_lshlrev_b32 v84, 16, v140
    v_and_b32 v85, 0xffff0000, v140
    v_lshlrev_b32 v86, 16, v141
    v_and_b32 v87, 0xffff0000, v141
    v_lshlrev_b32 v88, 16, v142
    v_and_b32 v89, 0xffff0000, v142
    v_lshlrev_b32 v90, 16, v143
    v_and_b32 v91, 0xffff0000, v143
    s_waitcnt lgkmcnt(4)
    v_lshlrev_b32 v92, 16, v144
    v_and_b32 v93, 0xffff0000, v144
    v_lshlrev_b32 v94, 16, v145
    v_and_b32 v95, 0xffff0000, v145
    v_lshlrev_b32 v96, 16, v146
    v_and_b32 v97, 0xffff0000, v146
    v_lshlrev_b32 v98, 16, v147
    v_and_b32 v99, 0xffff0000, v147
    s_waitcnt lgkmcnt(3)
    v_lshlrev_b32 v100, 16, v148
    v_and_b32 v101, 0xffff0000, v148
    v_lshlrev_b32 v102, 16, v149
    v_and_b32 v103, 0xffff0000, v149
    v_lshlrev_b32 v104, 16, v150
    v_and_b32 v105, 0xffff0000, v150
    v_lshlrev_b32 v106, 16, v151
    v_and_b32 v107, 0xffff0000, v151
    s_waitcnt lgkmcnt(2)
    v_lshlrev_b32 v108, 16, v152
    v_and_b32 v109, 0xffff0000, v152
    v_lshlrev_b32 v110, 16, v153
    v_and_b32 v111, 0xffff0000, v153
    v_lshlrev_b32 v112, 16, v154
    v_and_b32 v113, 0xffff0000, v154
    v_lshlrev_b32 v114, 16, v155
    v_and_b32 v115, 0xffff0000, v155
    s_waitcnt lgkmcnt(1)
    v_lshlrev_b32 v116, 16, v156
    v_and_b32 v117, 0xffff0000, v156
    v_lshlrev_b32 v118, 16, v157
    v_and_b32 v119, 0xffff0000, v157
    v_lshlrev_b32 v120, 16, v158
    v_and_b32 v121, 0xffff0000, v158
    v_lshlrev_b32 v122, 16, v159
    v_and_b32 v123, 0xffff0000, v159
    s_waitcnt lgkmcnt(0)
    v_lshlrev_b32 v124, 16, v160
    v_and_b32 v125, 0xffff0000, v160
    v_lshlrev_b32 v126, 16, v161
    v_and_b32 v127, 0xffff0000, v161
    v_lshlrev_b32 v128, 16, v162
    v_and_b32 v129, 0xffff0000, v162
    v_lshlrev_b32 v130, 16, v163
    v_and_b32 v131, 0xffff0000, v163
    v_max_f32 v12, v68, v69
    v_max3_f32 v12, v70, v71, v12
    v_max3_f32 v12, v72, v73, v12
    v_max3_f32 v12, v74, v75, v12
    v_max3_f32 v12, v76, v77, v12
    v_max3_f32 v12, v78, v79, v12
    v_max3_f32 v12, v80, v81, v12
    v_max3_f32 v12, v82, v83, v12
    v_max3_f32 v12, v84, v85, v12
    v_max3_f32 v12, v86, v87, v12
    v_max3_f32 v12, v88, v89, v12
    v_max3_f32 v12, v90, v91, v12
    v_max3_f32 v12, v92, v93, v12
    v_max3_f32 v12, v94, v95, v12
    v_max3_f32 v12, v96, v97, v12
    v_max3_f32 v12, v98, v99, v12
    v_max3_f32 v12, v100, v101, v12
    v_max3_f32 v12, v102, v103, v12
    v_max3_f32 v12, v104, v105, v12
    v_max3_f32 v12, v106, v107, v12
    v_max3_f32 v12, v108, v109, v12
    v_max3_f32 v12, v110, v111, v12
    v_max3_f32 v12, v112, v113, v12
    v_max3_f32 v12, v114, v115, v12
    v_max3_f32 v12, v116, v117, v12
    v_max3_f32 v12, v118, v119, v12
    v_max3_f32 v12, v120, v121, v12
    v_max3_f32 v12, v122, v123, v12
    v_max3_f32 v12, v124, v125, v12
    v_max3_f32 v12, v126, v127, v12
    v_max3_f32 v12, v128, v129, v12
    v_max3_f32 v12, v130, v131, v12
    s_nop 1
    v_max_f32_dpp v12, v12, v12 quad_perm:[1,0,3,2] row_mask:0xf bank_mask:0xf
    s_nop 1
    v_max_f32_dpp v12, v12, v12 row_ror:4 row_mask:0xf bank_mask:0xf
    s_nop 1
    v_max_f32_dpp v12, v12, v12 row_ror:8 row_mask:0xf bank_mask:0xf
    v_mov_b32 v4, v12
    s_nop 1
    v_permlane16_swap_b32 v12, v4
    s_nop 0
    v_max_f32 v12, v12, v4
    v_mov_b32 v4, v12
    s_nop 1
    v_permlane32_swap_b32 v12, v4
    s_nop 0
    v_max_f32 v12, v12, v4
    v_mul_f32 v12, s34, v12
    v_fma_f32 v68, v68, s34, -v12
    v_fma_f32 v69, v69, s34, -v12
    v_fma_f32 v70, v70, s34, -v12
    v_fma_f32 v71, v71, s34, -v12
    v_fma_f32 v72, v72, s34, -v12
    v_fma_f32 v73, v73, s34, -v12
    v_fma_f32 v74, v74, s34, -v12
    v_fma_f32 v75, v75, s34, -v12
    v_fma_f32 v76, v76, s34, -v12
    v_fma_f32 v77, v77, s34, -v12
    v_fma_f32 v78, v78, s34, -v12
    v_fma_f32 v79, v79, s34, -v12
    v_fma_f32 v80, v80, s34, -v12
    v_fma_f32 v81, v81, s34, -v12
    v_fma_f32 v82, v82, s34, -v12
    v_fma_f32 v83, v83, s34, -v12
    v_fma_f32 v84, v84, s34, -v12
    v_fma_f32 v85, v85, s34, -v12
    v_fma_f32 v86, v86, s34, -v12
    v_fma_f32 v87, v87, s34, -v12
    v_fma_f32 v88, v88, s34, -v12
    v_fma_f32 v89, v89, s34, -v12
    v_fma_f32 v90, v90, s34, -v12
    v_fma_f32 v91, v91, s34, -v12
    v_fma_f32 v92, v92, s34, -v12
    v_fma_f32 v93, v93, s34, -v12
    v_fma_f32 v94, v94, s34, -v12
    v_fma_f32 v95, v95, s34, -v12
    v_fma_f32 v96, v96, s34, -v12
    v_fma_f32 v97, v97, s34, -v12
    v_fma_f32 v98, v98, s34, -v12
    v_fma_f32 v99, v99, s34, -v12
    v_fma_f32 v100, v100, s34, -v12
    v_fma_f32 v101, v101, s34, -v12
    v_fma_f32 v102, v102, s34, -v12
    v_fma_f32 v103, v103, s34, -v12
    v_fma_f32 v104, v104, s34, -v12
    v_fma_f32 v105, v105, s34, -v12
    v_fma_f32 v106, v106, s34, -v12
    v_fma_f32 v107, v107, s34, -v12
    v_fma_f32 v108, v108, s34, -v12
    v_fma_f32 v109, v109, s34, -v12
    v_fma_f32 v110, v110, s34, -v12
    v_fma_f32 v111, v111, s34, -v12
    v_fma_f32 v112, v112, s34, -v12
    v_fma_f32 v113, v113, s34, -v12
    v_fma_f32 v114, v114, s34, -v12
    v_fma_f32 v115, v115, s34, -v12
    v_fma_f32 v116, v116, s34, -v12
    v_fma_f32 v117, v117, s34, -v12
    v_fma_f32 v118, v118, s34, -v12
    v_fma_f32 v119, v119, s34, -v12
    v_fma_f32 v120, v120, s34, -v12
    v_fma_f32 v121, v121, s34, -v12
    v_fma_f32 v122, v122, s34, -v12
    v_fma_f32 v123, v123, s34, -v12
    v_fma_f32 v124, v124, s34, -v12
    v_fma_f32 v125, v125, s34, -v12
    v_fma_f32 v126, v126, s34, -v12
    v_fma_f32 v127, v127, s34, -v12
    v_fma_f32 v128, v128, s34, -v12
    v_fma_f32 v129, v129, s34, -v12
    v_fma_f32 v130, v130, s34, -v12
    v_fma_f32 v131, v131, s34, -v12
    v_exp_f32 v68, v68
    v_exp_f32 v69, v69
    v_exp_f32 v70, v70
    v_exp_f32 v71, v71
    v_exp_f32 v72, v72
    v_exp_f32 v73, v73
    v_exp_f32 v74, v74
    v_exp_f32 v75, v75
    v_exp_f32 v76, v76
    v_exp_f32 v77, v77
    v_exp_f32 v78, v78
    v_exp_f32 v79, v79
    v_exp_f32 v80, v80
    v_exp_f32 v81, v81
    v_exp_f32 v82, v82
    v_exp_f32 v83, v83
    v_exp_f32 v84, v84
    v_exp_f32 v85, v85
    v_exp_f32 v86, v86
    v_exp_f32 v87, v87
    v_exp_f32 v88, v88
    v_exp_f32 v89, v89
    v_exp_f32 v90, v90
    v_exp_f32 v91, v91
    v_exp_f32 v92, v92
    v_exp_f32 v93, v93
    v_exp_f32 v94, v94
    v_exp_f32 v95, v95
    v_exp_f32 v96, v96
    v_exp_f32 v97, v97
    v_exp_f32 v98, v98
    v_exp_f32 v99, v99
    v_exp_f32 v100, v100
    v_exp_f32 v101, v101
    v_exp_f32 v102, v102
    v_exp_f32 v103, v103
    v_exp_f32 v104, v104
    v_exp_f32 v105, v105
    v_exp_f32 v106, v106
    v_exp_f32 v107, v107
    v_exp_f32 v108, v108
    v_exp_f32 v109, v109
    v_exp_f32 v110, v110
    v_exp_f32 v111, v111
    v_exp_f32 v112, v112
    v_exp_f32 v113, v113
    v_exp_f32 v114, v114
    v_exp_f32 v115, v115
    v_exp_f32 v116, v116
    v_exp_f32 v117, v117
    v_exp_f32 v118, v118
    v_exp_f32 v119, v119
    v_exp_f32 v120, v120
    v_exp_f32 v121, v121
    v_exp_f32 v122, v122
    v_exp_f32 v123, v123
    v_exp_f32 v124, v124
    v_exp_f32 v125, v125
    v_exp_f32 v126, v126
    v_exp_f32 v127, v127
    v_exp_f32 v128, v128
    v_exp_f32 v129, v129
    v_exp_f32 v130, v130
    v_exp_f32 v131, v131
    s_nop 0
    v_add_f32 v68, v68, v100
    v_add_f32 v69, v69, v101
    v_add_f32 v70, v70, v102
    v_add_f32 v71, v71, v103
    v_add_f32 v72, v72, v104
    v_add_f32 v73, v73, v105
    v_add_f32 v74, v74, v106
    v_add_f32 v75, v75, v107
    v_add_f32 v76, v76, v108
    v_add_f32 v77, v77, v109
    v_add_f32 v78, v78, v110
    v_add_f32 v79, v79, v111
    v_add_f32 v80, v80, v112
    v_add_f32 v81, v81, v113
    v_add_f32 v82, v82, v114
    v_add_f32 v83, v83, v115
    v_add_f32 v84, v84, v116
    v_add_f32 v85, v85, v117
    v_add_f32 v86, v86, v118
    v_add_f32 v87, v87, v119
    v_add_f32 v88, v88, v120
    v_add_f32 v89, v89, v121
    v_add_f32 v90, v90, v122
    v_add_f32 v91, v91, v123
    v_add_f32 v92, v92, v124
    v_add_f32 v93, v93, v125
    v_add_f32 v94, v94, v126
    v_add_f32 v95, v95, v127
    v_add_f32 v96, v96, v128
    v_add_f32 v97, v97, v129
    v_add_f32 v98, v98, v130
    v_add_f32 v99, v99, v131
    v_add_f32 v68, v68, v84
    v_add_f32 v69, v69, v85
    v_add_f32 v70, v70, v86
    v_add_f32 v71, v71, v87
    v_add_f32 v72, v72, v88
    v_add_f32 v73, v73, v89
    v_add_f32 v74, v74, v90
    v_add_f32 v75, v75, v91
    v_add_f32 v76, v76, v92
    v_add_f32 v77, v77, v93
    v_add_f32 v78, v78, v94
    v_add_f32 v79, v79, v95
    v_add_f32 v80, v80, v96
    v_add_f32 v81, v81, v97
    v_add_f32 v82, v82, v98
    v_add_f32 v83, v83, v99
    v_add_f32 v68, v68, v76
    v_add_f32 v69, v69, v77
    v_add_f32 v70, v70, v78
    v_add_f32 v71, v71, v79
    v_add_f32 v72, v72, v80
    v_add_f32 v73, v73, v81
    v_add_f32 v74, v74, v82
    v_add_f32 v75, v75, v83
    v_add_f32 v68, v68, v72
    v_add_f32 v69, v69, v73
    v_add_f32 v70, v70, v74
    v_add_f32 v71, v71, v75
    v_add_f32 v68, v68, v70
    v_add_f32 v69, v69, v71
    v_add_f32 v68, v68, v69
    s_nop 1
    v_add_f32_dpp v68, v68, v68 quad_perm:[1,0,3,2] row_mask:0xf bank_mask:0xf
    s_nop 1
    v_add_f32_dpp v68, v68, v68 row_ror:4 row_mask:0xf bank_mask:0xf
    s_nop 1
    v_add_f32_dpp v68, v68, v68 row_ror:8 row_mask:0xf bank_mask:0xf
    v_mov_b32 v4, v68
    s_nop 1
    v_permlane16_swap_b32 v68, v4
    s_nop 0
    v_add_f32 v68, v68, v4
    v_mov_b32 v4, v68
    s_nop 1
    v_permlane32_swap_b32 v68, v4
    s_nop 0
    v_add_f32 v68, v68, v4
    v_mov_b32 v13, s88
    v_mov_b32 v14, v68
    s_getreg_b32 s37, hwreg(HW_REG_XCC_ID)
    s_and_b32 s37, s37, 15
    s_xor_b32 s37, s37, s89
    v_mov_b32 v15, s37
    s_mov_b64 exec, 5
    buffer_store_dwordx4 v[12:15], v20, s[12:15], s35 offen sc1
    s_mov_b64 exec, -1
    s_mov_b32 s56, 16384
mlg_w_42:
    ds_read_b32 v4, v25 offset:2048
    ds_read_b32 v5, v25 offset:2560
    s_waitcnt lgkmcnt(0)
    v_add_u32 v4, v4, v5
    s_nop 0
    v_readfirstlane_b32 s52, v4
    s_cmp_ge_u32 s52, 144
    s_cbranch_scc1 mlg_g_43
    s_sub_u32 s56, s56, 1
    s_cbranch_scc1 mlg_g_43
    s_sleep 32
    s_branch mlg_w_42
mlg_g_43:
    s_mov_b32 s56, 16384
    buffer_load_dwordx4 v[28:31], v24, s[12:15], s36 offen
pml_44:
    s_waitcnt vmcnt(0)
    v_xor_b32 v4, s88, v29
    v_xor_b32 v5, s37, v31
    v_lshrrev_b32 v6, 4, v5
    v_or_b32 v4, v4, v6
    v_cmp_ne_u32 vcc, 0, v4
    s_mov_b64 exec, vcc
    s_cbranch_execz pml_done_45
    s_sub_u32 s56, s56, 1
    s_cbranch_scc1 pml_done_45
    s_sleep 32
    buffer_load_dwordx4 v[28:31], v24, s[12:15], s36 offen sc1
    s_branch pml_44
pml_done_45:
    s_mov_b64 exec, -1
    v_cmp_ne_u32 vcc, 0, v5
    s_cmp_eq_u64 vcc, 0
    s_cselect_b32 s38, 1, 0
    v_mov_b32 v12, v28
    s_nop 1
    v_max_f32_dpp v12, v12, v12 quad_perm:[2,3,0,1] row_mask:0xf bank_mask:0xf
    s_nop 1
    v_max_f32_dpp v12, v12, v12 row_ror:4 row_mask:0xf bank_mask:0xf
    s_nop 1
    v_max_f32_dpp v12, v12, v12 row_ror:8 row_mask:0xf bank_mask:0xf
    v_mov_b32 v4, v12
    s_nop 1
    v_permlane16_swap_b32 v12, v4
    s_nop 0
    v_max_f32 v12, v12, v4
    v_mov_b32 v4, v12
    s_nop 1
    v_permlane32_swap_b32 v12, v4
    s_nop 0
    v_max_f32 v12, v12, v4
    v_sub_f32 v28, v28, v12
    v_exp_f32 v28, v28
    s_nop 0
    v_mul_f32 v28, v28, v30
    s_nop 1
    v_add_f32_dpp v28, v28, v28 quad_perm:[2,3,0,1] row_mask:0xf bank_mask:0xf
    s_nop 1
    v_add_f32_dpp v28, v28, v28 row_ror:4 row_mask:0xf bank_mask:0xf
    s_nop 1
    v_add_f32_dpp v28, v28, v28 row_ror:8 row_mask:0xf bank_mask:0xf
    v_mov_b32 v4, v28
    s_nop 1
    v_permlane16_swap_b32 v28, v4
    s_nop 0
    v_add_f32 v28, v28, v4
    v_mov_b32 v4, v28
    s_nop 1
    v_permlane32_swap_b32 v28, v4
    s_nop 0
    v_add_f32 v28, v28, v4
    v_log_f32 v28, v28
    v_lshlrev_b32 v20, 2, v0
    v_mov_b32 v14, s88
    v_mov_b32 v15, s38
    v_add_f32 v28, v28, v12
    s_mov_b64 exec, 3
    ds_write_b32 v20, v28 offset:1056
    ds_write_b64 v25, v[14:15] offset:1064
    s_mov_b64 exec, -1
    v_lshrrev_b32 v22, 3, v0
    v_mul_u32_u24 v196, 4224, v22
    v_and_b32 v4, 7, v0
    v_lshl_add_u32 v196, v4, 4, v196
    s_lshr_b32 s28, s2, 5
    s_mul_i32 s28, s28, 135168
    s_and_b32 s29, s2, 31
    s_lshl_b32 s29, s29, 7
    s_add_u32 s28, s28, s29
    s_add_u32 s28, s28, 0xa0000
    s_add_u32 s29, s28, 33792
    s_add_u32 s30, s28, 67584
    s_add_u32 s31, s28, 101376
    s_lshl_b32 s21, s2, 7
    s_add_u32 s21, s21, 0x58000
    s_and_b32 s22, s2, 7
    s_cmp_lg_u32 s22, 3
    s_cselect_b32 s21, 0x40000000, s21
    v_lshlrev_b32 v20, 1, v0
    v_mov_b32 v22, s88
    s_cmp_lt_u32 s100, 200
    s_cbranch_scc1 nofin_33
    s_sub_u32 s55, s100, 200
    s_and_b32 s52, s55, 3
    s_mul_i32 s52, s52, 14
    s_lshr_b32 s53, s55, 2
    s_add_u32 s52, s52, s53
    s_lshl_b32 s52, s52, 14
    s_add_u32 s24, s52, 0x300000
    s_add_u32 s25, s52, 0x301000
    s_add_u32 s26, s52, 0x302000
    s_add_u32 s27, s52, 0x303000
    s_lshr_b32 s53, s55, 2
    s_lshl_b32 s53, s53, 6
    s_and_b32 s54, s55, 3
    s_lshl_b32 s54, s54, 2
    s_add_u32 s53, s53, s54
    v_lshrrev_b32 v21, 3, v0
    v_lshlrev_b32 v21, 12, v21
    v_and_b32 v19, 3, v0
    v_mul_u32_u24 v19, 1024, v19
    v_add_u32 v21, v21, v19
    s_mov_b32 s35, 0x58180
    s_mov_b64 s[32:33], 0
    s_mov_b64 exec, 0
dry_46:
    s_and_b32 s56, s32, 16384
fpa_w_47:
    ds_read_b32 v4, v25 offset:2048
    ds_read_b32 v5, v25 offset:2560
    s_waitcnt lgkmcnt(0)
    v_add_u32 v4, v4, v5
    s_nop 0
    v_readfirstlane_b32 s52, v4
    s_cmp_ge_u32 s52, 248
    s_cbranch_scc1 fpa_g_48
    s_sub_u32 s56, s56, 1
    s_cbranch_scc1 fpa_g_48
    s_sleep 32
    s_branch fpa_w_47
fpa_g_48:
    buffer_load_dword v19, v21, s[12:15], s35 offen sc1
    s_cmp_eq_u32 s38, 0
    s_cbranch_scc1 g_rem_49
    s_and_b32 s56, s32, 16384
p1w_w_52:
    ds_read_b32 v4, v25 offset:2048
    ds_read_b32 v5, v25 offset:2560
    s_waitcnt lgkmcnt(0)
    v_add_u32 v4, v4, v5
    s_nop 0
    v_readfirstlane_b32 s54, v4
    s_cmp_ge_u32 s54, 252
    s_cbranch_scc1 p1w_g_53
    s_sub_u32 s56, s56, 1
    s_cbranch_scc1 p1w_g_53
    s_sleep 2
    s_branch p1w_w_52
p1w_g_53:
    s_branch g_poll_50
g_rem_49:
    s_and_b32 s56, s32, 262144
g_w_51:
    ds_read_b32 v4, v25 offset:1036
    s_waitcnt lgkmcnt(0)
    v_readfirstlane_b32 s54, v4
    s_cmp_ge_u32 s54, 2
    s_cbranch_scc1 g_poll_50
    s_sub_u32 s56, s56, 1
    s_sleep 1
    s_cbranch_scc0 g_w_51
g_poll_50:
    s_and_b32 s56, s32, 16384
    buffer_load_dwordx4 v[28:31], v196, s[12:15], s28 offen sc1
    buffer_load_dwordx4 v[32:35], v196, s[12:15], s29 offen sc1
    buffer_load_dwordx4 v[36:39], v196, s[12:15], s30 offen sc1
    buffer_load_dwordx4 v[40:43], v196, s[12:15], s31 offen sc1
ps2_54:
    s_waitcnt vmcnt(0)
    v_xor_b32 v5, s88, v29
    v_xor_b32 v6, s89, v31
    v_or_b32 v4, v5, v6
    v_xor_b32 v5, s88, v33
    v_xor_b32 v6, s89, v35
    v_or3_b32 v4, v4, v5, v6
    v_xor_b32 v5, s88, v37
    v_xor_b32 v6, s89, v39
    v_or3_b32 v4, v4, v5, v6
    v_xor_b32 v5, s88, v41
    v_xor_b32 v6, s89, v43
    v_or3_b32 v4, v4, v5, v6
    v_cmp_ne_u32 vcc, 0, v4
    s_mov_b64 exec, vcc
    s_cbranch_execz ps2_done_55
    s_sub_u32 s56, s56, 1
    s_cbranch_scc1 ps2_done_55
    s_sleep 1
    buffer_load_dwordx4 v[28:31], v196, s[12:15], s28 offen sc1
    buffer_load_dwordx4 v[32:35], v196, s[12:15], s29 offen sc1
    buffer_load_dwordx4 v[36:39], v196, s[12:15], s30 offen sc1
    buffer_load_dwordx4 v[40:43], v196, s[12:15], s31 offen sc1
    s_branch ps2_54
ps2_done_55:
    s_mov_b64 exec, s[32:33]
    v_add_f32 v44, v28, v32
    v_add_f32 v46, v36, v40
    v_add_f32 v45, v30, v34
    v_add_f32 v47, v38, v42
    v_add_f32 v44, v44, v46
    v_add_f32 v45, v45, v47
    s_nop 1
    v_add_f32_dpp v44, v44, v44 row_ror:8 row_mask:0xf bank_mask:0xf
    v_add_f32_dpp v45, v45, v45 row_ror:8 row_mask:0xf bank_mask:0xf
    v_mov_b32 v52, v44
    v_mov_b32 v53, v45
    s_nop 1
    v_permlane16_swap_b32 v44, v52
    v_permlane16_swap_b32 v45, v53
    v_add_f32 v44, v44, v52
    v_add_f32 v45, v45, v53
    v_mov_b32 v52, v44
    v_mov_b32 v53, v45
    s_nop 1
    v_permlane32_swap_b32 v44, v52
    v_permlane32_swap_b32 v45, v53
    v_add_f32 v44, v44, v52
    v_add_f32 v45, v45, v53
    s_nop 0
    v_mov_b32_dpp v46, v44 quad_perm:[1,0,3,2] row_mask:0xf bank_mask:0xf
    v_mov_b32_dpp v47, v45 quad_perm:[1,0,3,2] row_mask:0xf bank_mask:0xf
    v_cvt_pk_bf16_f32 v4, v44, v46
    v_cvt_pk_bf16_f32 v5, v45, v47
    s_and_b64 exec, s[32:33], 0x55
    ds_write_b32 v20, v4 offset:1120
    ds_write_b32 v20, v5 offset:1136
    s_and_b64 exec, s[32:33], 0x1
    ds_write_b32 v25, v22 offset:1072
    buffer_store_dword v22, v25, s[12:15], s21 offen sc1
    s_mov_b64 exec, s[32:33]
    s_and_b32 s56, s32, 65536
b4_w_56:
    ds_read_b32 v4, v25 offset:1048
    s_waitcnt lgkmcnt(0)
    v_readfirstlane_b32 s54, v4
    s_cmp_eq_u32 s54, s88
    s_cbranch_scc1 b4_g_57
    s_sub_u32 s56, s56, 1
    s_sleep 1
    s_cbranch_scc0 b4_w_56
b4_g_57:
    s_and_b32 s56, s32, 16384
pf2_58:
    buffer_load_dword v19, v21, s[12:15], s35 offen sc1
    s_waitcnt vmcnt(0)
    v_xor_b32 v4, s88, v19
    v_cmp_ne_u32 vcc, 0, v4
    s_mov_b64 exec, vcc
    s_cbranch_execz pf2_done_59
    s_sub_u32 s56, s56, 1
    s_cbranch_scc1 pf2_done_59
    s_sleep 1
    s_branch pf2_58
pf2_done_59:
    s_mov_b64 exec, s[32:33]
    s_and_b32 s56, s32, 16384
    buffer_load_dwordx4 v[68:71], v24, s[12:15], s24 offen offset:0 sc1
    buffer_load_dwordx4 v[72:75], v24, s[12:15], s24 offen offset:1024 sc1
    buffer_load_dwordx4 v[76:79], v24, s[12:15], s24 offen offset:2048 sc1
    buffer_load_dwordx4 v[80:83], v24, s[12:15], s24 offen offset:3072 sc1
    buffer_load_dwordx4 v[84:87], v24, s[12:15], s25 offen offset:0 sc1
    buffer_load_dwordx4 v[88:91], v24, s[12:15], s25 offen offset:1024 sc1
    buffer_load_dwordx4 v[92:95], v24, s[12:15], s25 offen offset:2048 sc1
    buffer_load_dwordx4 v[96:99], v24, s[12:15], s25 offen offset:3072 sc1
    buffer_load_dwordx4 v[100:103], v24, s[12:15], s26 offen offset:0 sc1
    buffer_load_dwordx4 v[104:107], v24, s[12:15], s26 offen offset:1024 sc1
    buffer_load_dwordx4 v[108:111], v24, s[12:15], s26 offen offset:2048 sc1
    buffer_load_dwordx4 v[112:115], v24, s[12:15], s26 offen offset:3072 sc1
    buffer_load_dwordx4 v[116:119], v24, s[12:15], s27 offen offset:0 sc1
    buffer_load_dwordx4 v[120:123], v24, s[12:15], s27 offen offset:1024 sc1
    buffer_load_dwordx4 v[124:127], v24, s[12:15], s27 offen offset:2048 sc1
    buffer_load_dwordx4 v[128:131], v24, s[12:15], s27 offen offset:3072 sc1
py_60:
    s_waitcnt vmcnt(12)
    v_xor_b32 v5, s88, v69
    v_xor_b32 v6, s89, v71
    v_or_b32 v4, v5, v6
    v_xor_b32 v5, s88, v73
    v_xor_b32 v6, s89, v75
    v_or3_b32 v4, v4, v5, v6
    v_xor_b32 v5, s88, v77
    v_xor_b32 v6, s89, v79
    v_or3_b32 v4, v4, v5, v6
    v_xor_b32 v5, s88, v81
    v_xor_b32 v6, s89, v83
    v_or3_b32 v4, v4, v5, v6
    s_waitcnt vmcnt(8)
    v_xor_b32 v5, s88, v85
    v_xor_b32 v6, s89, v87
    v_or3_b32 v4, v4, v5, v6
    v_xor_b32 v5, s88, v89
    v_xor_b32 v6, s89, v91
    v_or3_b32 v4, v4, v5, v6
    v_xor_b32 v5, s88, v93
    v_xor_b32 v6, s89, v95
    v_or3_b32 v4, v4, v5, v6
    v_xor_b32 v5, s88, v97
    v_xor_b32 v6, s89, v99
    v_or3_b32 v4, v4, v5, v6
    s_waitcnt vmcnt(4)
    v_xor_b32 v5, s88, v101
    v_xor_b32 v6, s89, v103
    v_or3_b32 v4, v4, v5, v6
    v_xor_b32 v5, s88, v105
    v_xor_b32 v6, s89, v107
    v_or3_b32 v4, v4, v5, v6
    v_xor_b32 v5, s88, v109
    v_xor_b32 v6, s89, v111
    v_or3_b32 v4, v4, v5, v6
    v_xor_b32 v5, s88, v113
    v_xor_b32 v6, s89, v115
    v_or3_b32 v4, v4, v5, v6
    s_waitcnt vmcnt(0)
    v_xor_b32 v5, s88, v117
    v_xor_b32 v6, s89, v119
    v_or3_b32 v4, v4, v5, v6
    v_xor_b32 v5, s88, v121
    v_xor_b32 v6, s89, v123
    v_or3_b32 v4, v4, v5, v6
    v_xor_b32 v5, s88, v125
    v_xor_b32 v6, s89, v127
    v_or3_b32 v4, v4, v5, v6
    v_xor_b32 v5, s88, v129
    v_xor_b32 v6, s89, v131
    v_or3_b32 v4, v4, v5, v6
    v_cmp_ne_u32 vcc, 0, v4
    s_mov_b64 exec, vcc
    s_cbranch_execz py_done_61
    s_sub_u32 s56, s56, 1
    s_cbranch_scc1 py_done_61
    s_sleep 1
    buffer_load_dwordx4 v[68:71], v24, s[12:15], s24 offen offset:0 sc1
    buffer_load_dwordx4 v[72:75], v24, s[12:15], s24 offen offset:1024 sc1
    buffer_load_dwordx4 v[76:79], v24, s[12:15], s24 offen offset:2048 sc1
    buffer_load_dwordx4 v[80:83], v24, s[12:15], s24 offen offset:3072 sc1
    buffer_load_dwordx4 v[84:87], v24, s[12:15], s25 offen offset:0 sc1
    buffer_load_dwordx4 v[88:91], v24, s[12:15], s25 offen offset:1024 sc1
    buffer_load_dwordx4 v[92:95], v24, s[12:15], s25 offen offset:2048 sc1
    buffer_load_dwordx4 v[96:99], v24, s[12:15], s25 offen offset:3072 sc1
    buffer_load_dwordx4 v[100:103], v24, s[12:15], s26 offen offset:0 sc1
    buffer_load_dwordx4 v[104:107], v24, s[12:15], s26 offen offset:1024 sc1
    buffer_load_dwordx4 v[108:111], v24, s[12:15], s26 offen offset:2048 sc1
    buffer_load_dwordx4 v[112:115], v24, s[12:15], s26 offen offset:3072 sc1
    buffer_load_dwordx4 v[116:119], v24, s[12:15], s27 offen offset:0 sc1
    buffer_load_dwordx4 v[120:123], v24, s[12:15], s27 offen offset:1024 sc1
    buffer_load_dwordx4 v[124:127], v24, s[12:15], s27 offen offset:2048 sc1
    buffer_load_dwordx4 v[128:131], v24, s[12:15], s27 offen offset:3072 sc1
    s_branch py_60
py_done_61:
    s_mov_b64 exec, s[32:33]
    v_add_f32 v12, v68, v72
    v_add_f32 v14, v76, v80
    v_add_f32 v13, v70, v74
    v_add_f32 v15, v78, v82
    v_add_f32 v12, v12, v84
    v_add_f32 v13, v13, v86
    v_add_f32 v14, v14, v88
    v_add_f32 v15, v15, v90
    v_add_f32 v12, v12, v92
    v_add_f32 v13, v13, v94
    v_add_f32 v14, v14, v96
    v_add_f32 v15, v15, v98
    v_add_f32 v12, v12, v100
    v_add_f32 v13, v13, v102
    v_add_f32 v14, v14, v104
    v_add_f32 v15, v15, v106
    v_add_f32 v12, v12, v108
    v_add_f32 v13, v13, v110
    v_add_f32 v14, v14, v112
    v_add_f32 v15, v15, v114
    v_add_f32 v12, v12, v116
    v_add_f32 v13, v13, v118
    v_add_f32 v14, v14, v120
    v_add_f32 v15, v15, v122
    v_add_f32 v12, v12, v124
    v_add_f32 v13, v13, v126
    v_add_f32 v14, v14, v128
    v_add_f32 v15, v15, v130
    v_add_f32 v12, v12, v14
    v_add_f32 v13, v13, v15
    s_nop 1
    v_add_f32_dpp v12, v12, v12 row_ror:4 row_mask:0xf bank_mask:0xf
    v_add_f32_dpp v13, v13, v13 row_ror:4 row_mask:0xf bank_mask:0xf
    s_nop 1
    v_add_f32_dpp v12, v12, v12 row_ror:8 row_mask:0xf bank_mask:0xf
    v_add_f32_dpp v13, v13, v13 row_ror:8 row_mask:0xf bank_mask:0xf
    v_mov_b32 v16, v12
    v_mov_b32 v17, v13
    s_nop 1
    v_permlane16_swap_b32 v12, v16
    v_permlane16_swap_b32 v13, v17
    v_add_f32 v12, v12, v16
    v_add_f32 v13, v13, v17
    v_mov_b32 v16, v12
    v_mov_b32 v17, v13
    s_nop 1
    v_permlane32_swap_b32 v12, v16
    v_permlane32_swap_b32 v13, v17
    v_add_f32 v12, v12, v16
    v_add_f32 v13, v13, v17
    v_cvt_pk_bf16_f32 v4, v12, v13
    s_and_b64 exec, s[32:33], 0xf
    buffer_store_dword v4, v24, s[72:75], s53 offen
    s_mov_b64 exec, s[32:33]
    s_cmp_lg_u32 s32, 0
    s_cbranch_scc1 dry_d_62
    s_mov_b64 s[32:33], -1
    s_mov_b64 exec, -1
    s_branch dry_46
dry_d_62:
    s_endpgm
nofin_33:
    s_mov_b64 s[32:33], 0
    s_mov_b64 exec, 0
dry_63:
    s_cmp_eq_u32 s38, 0
    s_cbranch_scc1 g_rem_64
    s_and_b32 s56, s32, 16384
p1w_w_67:
    ds_read_b32 v4, v25 offset:2048
    ds_read_b32 v5, v25 offset:2560
    s_waitcnt lgkmcnt(0)
    v_add_u32 v4, v4, v5
    s_nop 0
    v_readfirstlane_b32 s54, v4
    s_cmp_ge_u32 s54, 252
    s_cbranch_scc1 p1w_g_68
    s_sub_u32 s56, s56, 1
    s_cbranch_scc1 p1w_g_68
    s_sleep 2
    s_branch p1w_w_67
p1w_g_68:
    s_branch g_poll_65
g_rem_64:
    s_and_b32 s56, s32, 262144
g_w_66:
    ds_read_b32 v4, v25 offset:1036
    s_waitcnt lgkmcnt(0)
    v_readfirstlane_b32 s54, v4
    s_cmp_ge_u32 s54, 2
    s_cbranch_scc1 g_poll_65
    s_sub_u32 s56, s56, 1
    s_sleep 1
    s_cbranch_scc0 g_w_66
g_poll_65:
    s_and_b32 s56, s32, 16384
    buffer_load_dwordx4 v[28:31], v196, s[12:15], s28 offen sc1
    buffer_load_dwordx4 v[32:35], v196, s[12:15], s29 offen sc1
    buffer_load_dwordx4 v[36:39], v196, s[12:15], s30 offen sc1
    buffer_load_dwordx4 v[40:43], v196, s[12:15], s31 offen sc1
ps2_69:
    s_waitcnt vmcnt(0)
    v_xor_b32 v5, s88, v29
    v_xor_b32 v6, s89, v31
    v_or_b32 v4, v5, v6
    v_xor_b32 v5, s88, v33
    v_xor_b32 v6, s89, v35
    v_or3_b32 v4, v4, v5, v6
    v_xor_b32 v5, s88, v37
    v_xor_b32 v6, s89, v39
    v_or3_b32 v4, v4, v5, v6
    v_xor_b32 v5, s88, v41
    v_xor_b32 v6, s89, v43
    v_or3_b32 v4, v4, v5, v6
    v_cmp_ne_u32 vcc, 0, v4
    s_mov_b64 exec, vcc
    s_cbranch_execz ps2_done_70
    s_sub_u32 s56, s56, 1
    s_cbranch_scc1 ps2_done_70
    s_sleep 1
    buffer_load_dwordx4 v[28:31], v196, s[12:15], s28 offen sc1
    buffer_load_dwordx4 v[32:35], v196, s[12:15], s29 offen sc1
    buffer_load_dwordx4 v[36:39], v196, s[12:15], s30 offen sc1
    buffer_load_dwordx4 v[40:43], v196, s[12:15], s31 offen sc1
    s_branch ps2_69
ps2_done_70:
    s_mov_b64 exec, s[32:33]
    v_add_f32 v44, v28, v32
    v_add_f32 v46, v36, v40
    v_add_f32 v45, v30, v34
    v_add_f32 v47, v38, v42
    v_add_f32 v44, v44, v46
    v_add_f32 v45, v45, v47
    s_nop 1
    v_add_f32_dpp v44, v44, v44 row_ror:8 row_mask:0xf bank_mask:0xf
    v_add_f32_dpp v45, v45, v45 row_ror:8 row_mask:0xf bank_mask:0xf
    v_mov_b32 v52, v44
    v_mov_b32 v53, v45
    s_nop 1
    v_permlane16_swap_b32 v44, v52
    v_permlane16_swap_b32 v45, v53
    v_add_f32 v44, v44, v52
    v_add_f32 v45, v45, v53
    v_mov_b32 v52, v44
    v_mov_b32 v53, v45
    s_nop 1
    v_permlane32_swap_b32 v44, v52
    v_permlane32_swap_b32 v45, v53
    v_add_f32 v44, v44, v52
    v_add_f32 v45, v45, v53
    s_nop 0
    v_mov_b32_dpp v46, v44 quad_perm:[1,0,3,2] row_mask:0xf bank_mask:0xf
    v_mov_b32_dpp v47, v45 quad_perm:[1,0,3,2] row_mask:0xf bank_mask:0xf
    v_cvt_pk_bf16_f32 v4, v44, v46
    v_cvt_pk_bf16_f32 v5, v45, v47
    s_and_b64 exec, s[32:33], 0x55
    ds_write_b32 v20, v4 offset:1120
    ds_write_b32 v20, v5 offset:1136
    s_and_b64 exec, s[32:33], 0x1
    ds_write_b32 v25, v22 offset:1072
    buffer_store_dword v22, v25, s[12:15], s21 offen sc1
    s_mov_b64 exec, s[32:33]
    s_cmp_lg_u32 s32, 0
    s_cbranch_scc1 dry_d_71
    s_mov_b64 s[32:33], -1
    s_mov_b64 exec, -1
    s_branch dry_63
dry_d_71:
    s_endpgm
L_end:
    s_endpgm
.section .rodata,"a"
.p2align 6
.amdhsa_kernel gated_mix__gqa_block_cached__geglu_ffn__decode_kernel
  .amdhsa_next_free_vgpr 484
  .amdhsa_next_free_sgpr 102
  .amdhsa_accum_offset 228
  .amdhsa_group_segment_fixed_size 0
  .amdhsa_kernarg_size 104
  .amdhsa_user_sgpr_count 2
  .amdhsa_user_sgpr_kernarg_segment_ptr 1
  .amdhsa_system_sgpr_workgroup_id_x 1
.end_amdhsa_kernel
```
